```python
import torch

def _softmax(x, axis=-1):
    return torch.softmax(x, dim=axis)
def _gelu(x):
    return torch.nn.functional.gelu(x, approximate="tanh")
def _silu(x):
    return torch.nn.functional.silu(x)
def _sigmoid(x):
    return torch.sigmoid(x)
def _layernorm(x, axis=-1, eps=1e-5):
    m = x.mean(dim=axis, keepdim=True)
    v = x.var(dim=axis, keepdim=True, unbiased=False)
    return (x - m) / torch.sqrt(v + eps)
def _scatter_add(tgt, idx, src, axis=0):
    return tgt.clone().index_add_(axis, idx, src)
def _segment_sum(src, seg, n):
    out = torch.zeros((n,) + src.shape[1:], dtype=src.dtype)
    return out.index_add_(0, seg, src)
def _pad(x, pw):
    flat = tuple(v for pair in reversed(pw) for v in pair)
    return torch.nn.functional.pad(x, flat)

kernel_name = 'sequential_preLN__sliding_block_cached__dense_activation_gelu__decode'

def setup_inputs():

    _w = (lambda a: (lambda t: t.to(torch.bfloat16) if t.is_floating_point() else t)(torch.as_tensor(a)))
    def _A_setup():
        B, Sq, D = 2, 1, 512
        Hq, Hkv, Sk, Dh = 32, 8, 8192, 128
        assert Hq % Hkv == 0, (Hq, Hkv)
        return {
            "x": _w((lambda *s: torch.randn(*s, dtype=torch.bfloat16) * 0.05)(B, Sq, D)),
            "k_cache": _w((lambda *s: torch.randn(*s, dtype=torch.bfloat16) * 3.2)(B, Hkv, Sk, Dh)),
            "v_cache": _w((lambda *s: torch.randn(*s, dtype=torch.bfloat16) * 0.8)(B, Hkv, Sk, Dh)),
            "wq": _w((lambda *s: torch.randn(*s, dtype=torch.bfloat16) * 3.2)(D, Hq * Dh) * (D ** -0.5)),
            "wo": _w((lambda *s: torch.randn(*s, dtype=torch.bfloat16) * 0.8)(Hq * Dh, D) * ((Hq * Dh) ** -0.5)),
        }
    _A_in = _A_setup()

    def _B_setup():
        B, S, D, F = 2, 1, 512, 1792
        return {
            "x": _w((lambda *s: torch.randn(*s, dtype=torch.bfloat16) * 0.05)(B, S, D)),
            "w1": _w((lambda *s: torch.randn(*s, dtype=torch.bfloat16) * 3.2)(D, F) * (D ** -0.5)),
            "b1": _w((lambda *s: torch.randn(*s, dtype=torch.bfloat16) * 3.2)(F) * 0.01),
            "w2": _w((lambda *s: torch.randn(*s, dtype=torch.bfloat16) * 0.4)(F, D) * (F ** -0.5)),
            "b2": _w((lambda *s: torch.randn(*s, dtype=torch.bfloat16) * 0.4)(D) * 0.01),
        }
    _B_in = _B_setup()

    return {
        "A_x": _A_in["x"],
        "A_k_cache": _A_in["k_cache"],
        "A_v_cache": _A_in["v_cache"],
        "A_wq": _A_in["wq"],
        "A_wo": _A_in["wo"],
        "B_x": _B_in["x"],
        "B_w1": _B_in["w1"],
        "B_b1": _B_in["b1"],
        "B_w2": _B_in["w2"],
        "B_b2": _B_in["b2"],
    }

def reference(A_x, A_k_cache, A_v_cache, A_wq, A_wo, B_x, B_w1, B_b1, B_w2, B_b2):
    def _A_ref(x, k_cache, v_cache, wq, wo):
        B, Sq, D = x.shape
        Hq, Dh = 32, 128
        Hkv, Sk = k_cache.shape[1], k_cache.shape[2]
        W = min(4096, max(256, Sk // 4))
        rep = Hq // Hkv
        q = (lambda x, *d: x.permute(*d))((x @ wq).reshape(B, Sq, Hq, Dh), 0, 2, 1, 3)
        k = (lambda x, n, axis: torch.repeat_interleave(x, n, dim=axis))(k_cache[:, :, Sk - W:, :], rep, axis=1)
        v = (lambda x, n, axis: torch.repeat_interleave(x, n, dim=axis))(v_cache[:, :, Sk - W:, :], rep, axis=1)
        scores = torch.einsum("bhqd,bhkd->bhqk", q, k) * (Dh ** -0.5)
        p = _softmax(scores, axis=-1)
        o = torch.einsum("bhqk,bhkd->bhqd", p, v)
        return (lambda x, *d: x.permute(*d))(o, 0, 2, 1, 3).reshape(B, Sq, Hq * Dh) @ wo

    def _B_ref(x, w1, b1, w2, b2):
        h = torch.einsum("bsd,df->bsf", x, w1) + b1
        h = _gelu(h)
        return torch.einsum("bsf,fd->bsd", h, w2) + b2

    x = A_x
    h = x + _A_ref(_layernorm(x, axis=-1), A_k_cache, A_v_cache, A_wq, A_wo)
    h2 = h + _B_ref(_layernorm(h, axis=-1), B_w1, B_b1, B_w2, B_b2)
    return h2
```

```asm
; @launch grid=(256,1,1) block=(640,1,1) lds=142336
.amdgcn_target "amdgcn-amd-amdhsa--gfx950"
.text
.globl sequential_preLN__sliding_block_cached__dense_activation_gelu__decode_kernel
.p2align 8
.type sequential_preLN__sliding_block_cached__dense_activation_gelu__decode_kernel,@function
sequential_preLN__sliding_block_cached__dense_activation_gelu__decode_kernel:
    s_cmp_ge_u32 s2, 256
    s_cbranch_scc1 L_end
    s_load_dwordx16 s[36:51], s[0:1], 0
    s_load_dwordx8 s[52:59], s[0:1], 64
    s_load_dwordx2 s[60:61], s[0:1], 96
    v_lshrrev_b32 v1, 6, v0
    v_and_b32 v0, 63, v0
    s_and_b32 s4, s2, 7
    v_readfirstlane_b32 s3, v1
    s_lshr_b32 s5, s2, 3
    v_lshlrev_b32 v2, 4, v0
    v_lshrrev_b32 v4, 4, v0
    v_mov_b32 v5, 0x3ff
    v_and_b32 v6, 15, v0
    v_lshrrev_b32 v8, 3, v0
    v_bfe_u32 v9, v0, 1, 2
    v_and_b32 v10, 1, v0
    v_lshlrev_b32 v11, 5, v8
    v_lshl_add_u32 v11, v10, 4, v11
    s_lshr_b32 s24, s5, 4
    s_lshl_b32 s24, s24, 4
    s_or_b32 s24, s24, s3
    s_cmp_ge_u32 s24, 24
    s_cbranch_scc1 L_ldr
    s_cmp_ge_u32 s24, 16
    s_cbranch_scc1 L_att
    s_cmp_lg_u32 s24, 5
    s_cbranch_scc1 L_nd
    s_mov_b64 exec, 0
    s_branch L_dry
L_nd:
    s_cmp_lg_u32 s24, 6
    s_cbranch_scc1 L_GV
    v_mov_b32 v16, 0
    v_mov_b32 v17, 0
    ds_write_b64 v16, v[16:17] offset:10512
    s_waitcnt lgkmcnt(0)
    s_mov_b32 s8, s60
    s_mov_b32 s9, s61
    s_mov_b32 s10, 0x200000
    s_mov_b32 s11, 0x00020000
    s_mov_b32 s12, s36
    s_mov_b32 s13, s37
    s_mov_b32 s14, 0x800
    s_mov_b32 s15, 0x00020000
    buffer_load_dwordx4 v[16:19], v2, s[12:15], 0 offen
    buffer_load_dwordx4 v[20:23], v2, s[12:15], 0 offen offset:1024
    s_lshl_b32 s25, s4, 4
    s_add_u32 s25, s25, s5
    s_lshl_b32 s25, s25, 9
    s_add_u32 s25, s25, 589824
    s_mov_b32 exec_hi, 0
    buffer_load_dwordx4 v[72:75], v2, s[8:11], s25 offen sc1
    s_mov_b32 exec_hi, -1
    s_mov_b32 s16, s42
    s_mov_b32 s17, s43
    s_mov_b32 s18, 0x400000
    s_mov_b32 s19, 0x00020000
    v_bfe_u32 v13, v0, 1, 3
    v_lshlrev_b32 v13, 13, v13
    v_lshl_add_u32 v13, v4, 5, v13
    v_lshl_add_u32 v13, v10, 4, v13
    s_and_b32 s6, s5, 1
    s_lshl_b32 s24, s6, 21
    s_lshl_b32 s25, s4, 10
    s_add_u32 s24, s24, s25
    s_lshr_b32 s25, s5, 1
    s_lshl_b32 s25, s25, 7
    s_add_u32 s24, s24, s25
    s_mov_b32 s25, 11264
L_qc1:
    s_mov_b32 m0, s25
    s_add_u32 s25, s25, 1024
    buffer_load_dwordx4 v13, s[16:19], s24 offen nt lds
    s_add_u32 s24, s24, 0x10000
    s_mov_b32 m0, s25
    s_add_u32 s25, s25, 1024
    buffer_load_dwordx4 v13, s[16:19], s24 offen nt lds
    s_add_u32 s24, s24, 0x10000
    s_mov_b32 m0, s25
    s_add_u32 s25, s25, 1024
    buffer_load_dwordx4 v13, s[16:19], s24 offen nt lds
    s_add_u32 s24, s24, 0x10000
    s_mov_b32 m0, s25
    s_add_u32 s25, s25, 1024
    buffer_load_dwordx4 v13, s[16:19], s24 offen nt lds
    s_add_u32 s24, s24, 0x10000
    s_cmp_lt_u32 s25, 44032
    s_cbranch_scc1 L_qc1
L_dry:
    s_mul_i32 s32, s4, 7
    s_add_u32 s32, s32, s5
    s_sub_u32 s32, s32, 8
    s_mov_b32 s31, 2
    s_cmp_lt_u32 s5, 8
    s_cselect_b32 s31, 1, s31
    s_cselect_b32 s32, s5, s32
    s_cmp_eq_u32 s5, 15
    s_cselect_b32 s31, 0, s31
    v_lshrrev_b32 v12, 2, v0
    v_lshlrev_b32 v12, 6, v12
    v_lshl_add_u32 v12, v10, 5, v12
    v_bfe_u32 v13, v0, 1, 1
    v_lshl_add_u32 v12, v13, 3, v12
    v_lshlrev_b32 v13, 10, v10
    v_lshl_add_u32 v13, v4, 4, v13
    s_lshl_b32 s25, s6, 9
    v_add_u32 v13, s25, v13
    v_lshrrev_b32 v14, 5, v0
    v_lshlrev_b32 v14, 10, v14
    v_and_b32 v15, 31, v0
    v_lshl_add_u32 v14, v15, 3, v14
    v_bfe_u32 v70, v0, 2, 1
    v_lshlrev_b32 v69, 6, v70
    v_lshl_add_u32 v69, v4, 4, v69
    v_lshl_add_u32 v69, v10, 11, v69
    v_lshlrev_b32 v70, 8, v70
    v_lshl_add_u32 v70, v10, 7, v70
    v_lshl_add_u32 v70, v4, 5, v70
    v_bfe_u32 v15, v0, 1, 1
    v_lshl_add_u32 v70, v15, 4, v70
    s_lshl_b32 s29, s4, 12
    s_lshl_b32 s25, s5, 7
    s_add_u32 s29, s29, s25
    s_lshl_b32 s25, s4, 4
    s_add_u32 s25, s25, s5
    s_lshl_b32 s62, s25, 9
    s_xor_b32 s63, s62, 512
    s_add_u32 s64, s62, 524288
    s_add_u32 s62, s62, 589824
    s_add_u32 s65, s63, 524288
    s_add_u32 s63, s63, 589824
    s_mov_b32 s66, 0xcccccccc
    s_mov_b32 s67, 0xcccccccc
    s_mov_b32 s68, 0xf0f0f0f0
    s_mov_b32 s69, 0xf0f0f0f0
    s_waitcnt vmcnt(33)
    v_lshlrev_b32 v24, 16, v16
    v_and_b32 v25, 0xffff0000, v16
    v_lshlrev_b32 v26, 16, v17
    v_and_b32 v27, 0xffff0000, v17
    v_lshlrev_b32 v28, 16, v18
    v_and_b32 v29, 0xffff0000, v18
    v_lshlrev_b32 v30, 16, v19
    v_and_b32 v31, 0xffff0000, v19
    v_lshlrev_b32 v32, 16, v20
    v_and_b32 v33, 0xffff0000, v20
    v_lshlrev_b32 v34, 16, v21
    v_and_b32 v35, 0xffff0000, v21
    v_lshlrev_b32 v36, 16, v22
    v_and_b32 v37, 0xffff0000, v22
    v_lshlrev_b32 v38, 16, v23
    v_and_b32 v39, 0xffff0000, v23
    v_add_f32 v44, v24, v25
    v_add_f32 v48, v26, v27
    v_add_f32 v46, v28, v29
    v_add_f32 v50, v30, v31
    v_add_f32 v44, v44, v48
    v_add_f32 v46, v46, v50
    v_add_f32 v44, v44, v46
    v_add_f32 v45, v32, v33
    v_add_f32 v49, v34, v35
    v_add_f32 v47, v36, v37
    v_add_f32 v51, v38, v39
    v_add_f32 v45, v45, v49
    v_add_f32 v47, v47, v51
    v_add_f32 v45, v45, v47
    s_nop 1
    s_nop 0
    v_add_f32_dpp v44, v44, v44 quad_perm:[1,0,3,2] row_mask:0xf bank_mask:0xf
    v_add_f32_dpp v45, v45, v45 quad_perm:[1,0,3,2] row_mask:0xf bank_mask:0xf
    s_nop 0
    v_add_f32_dpp v44, v44, v44 quad_perm:[2,3,0,1] row_mask:0xf bank_mask:0xf
    v_add_f32_dpp v45, v45, v45 quad_perm:[2,3,0,1] row_mask:0xf bank_mask:0xf
    s_nop 0
    v_add_f32_dpp v44, v44, v44 row_half_mirror row_mask:0xf bank_mask:0xf
    v_add_f32_dpp v45, v45, v45 row_half_mirror row_mask:0xf bank_mask:0xf
    s_nop 0
    v_add_f32_dpp v44, v44, v44 row_mirror row_mask:0xf bank_mask:0xf
    v_add_f32_dpp v45, v45, v45 row_mirror row_mask:0xf bank_mask:0xf
    v_mov_b32 v48, v44
    v_mov_b32 v49, v45
    s_nop 0
    v_permlane16_swap_b32 v44, v48
    v_permlane16_swap_b32 v45, v49
    v_add_f32 v44, v44, v48
    v_add_f32 v45, v45, v49
    v_mov_b32 v48, v44
    v_mov_b32 v49, v45
    s_nop 0
    v_permlane32_swap_b32 v44, v48
    v_permlane32_swap_b32 v45, v49
    v_add_f32 v44, v44, v48
    v_add_f32 v45, v45, v49
    v_mul_f32 v44, 0x3b000000, v44
    v_mul_f32 v45, 0x3b000000, v45
    v_sub_f32 v52, v24, v44
    v_sub_f32 v53, v25, v44
    v_sub_f32 v54, v26, v44
    v_sub_f32 v55, v27, v44
    v_sub_f32 v56, v28, v44
    v_sub_f32 v57, v29, v44
    v_sub_f32 v58, v30, v44
    v_sub_f32 v59, v31, v44
    v_mul_f32 v46, v52, v52
    v_fmac_f32 v46, v53, v53
    v_fmac_f32 v46, v54, v54
    v_fmac_f32 v46, v55, v55
    v_fmac_f32 v46, v56, v56
    v_fmac_f32 v46, v57, v57
    v_fmac_f32 v46, v58, v58
    v_fmac_f32 v46, v59, v59
    v_cvt_pk_bf16_f32 v50, v44, v44
    v_lshlrev_b32 v50, 16, v50
    v_sub_f32 v60, v32, v45
    v_sub_f32 v61, v33, v45
    v_sub_f32 v62, v34, v45
    v_sub_f32 v63, v35, v45
    v_sub_f32 v64, v36, v45
    v_sub_f32 v65, v37, v45
    v_sub_f32 v66, v38, v45
    v_sub_f32 v67, v39, v45
    v_mul_f32 v47, v60, v60
    v_fmac_f32 v47, v61, v61
    v_fmac_f32 v47, v62, v62
    v_fmac_f32 v47, v63, v63
    v_fmac_f32 v47, v64, v64
    v_fmac_f32 v47, v65, v65
    v_fmac_f32 v47, v66, v66
    v_fmac_f32 v47, v67, v67
    v_cvt_pk_bf16_f32 v51, v45, v45
    v_lshlrev_b32 v51, 16, v51
    s_nop 1
    s_nop 0
    v_add_f32_dpp v46, v46, v46 quad_perm:[1,0,3,2] row_mask:0xf bank_mask:0xf
    v_add_f32_dpp v47, v47, v47 quad_perm:[1,0,3,2] row_mask:0xf bank_mask:0xf
    s_nop 0
    v_add_f32_dpp v46, v46, v46 quad_perm:[2,3,0,1] row_mask:0xf bank_mask:0xf
    v_add_f32_dpp v47, v47, v47 quad_perm:[2,3,0,1] row_mask:0xf bank_mask:0xf
    s_nop 0
    v_add_f32_dpp v46, v46, v46 row_half_mirror row_mask:0xf bank_mask:0xf
    v_add_f32_dpp v47, v47, v47 row_half_mirror row_mask:0xf bank_mask:0xf
    s_nop 0
    v_add_f32_dpp v46, v46, v46 row_mirror row_mask:0xf bank_mask:0xf
    v_add_f32_dpp v47, v47, v47 row_mirror row_mask:0xf bank_mask:0xf
    v_sub_f32 v52, v24, v50
    v_sub_f32 v53, v25, v50
    v_sub_f32 v54, v26, v50
    v_sub_f32 v55, v27, v50
    v_sub_f32 v56, v28, v50
    v_sub_f32 v57, v29, v50
    v_sub_f32 v58, v30, v50
    v_sub_f32 v59, v31, v50
    v_cvt_pk_bf16_f32 v16, v52, v53
    v_cvt_pk_bf16_f32 v17, v54, v55
    v_cvt_pk_bf16_f32 v18, v56, v57
    v_cvt_pk_bf16_f32 v19, v58, v59
    v_lshlrev_b32 v52, 16, v16
    v_and_b32 v53, 0xffff0000, v16
    v_lshlrev_b32 v54, 16, v17
    v_and_b32 v55, 0xffff0000, v17
    v_lshlrev_b32 v56, 16, v18
    v_and_b32 v57, 0xffff0000, v18
    v_lshlrev_b32 v58, 16, v19
    v_and_b32 v59, 0xffff0000, v19
    v_sub_f32 v60, v32, v51
    v_sub_f32 v61, v33, v51
    v_sub_f32 v62, v34, v51
    v_sub_f32 v63, v35, v51
    v_sub_f32 v64, v36, v51
    v_sub_f32 v65, v37, v51
    v_sub_f32 v66, v38, v51
    v_sub_f32 v67, v39, v51
    v_cvt_pk_bf16_f32 v20, v60, v61
    v_cvt_pk_bf16_f32 v21, v62, v63
    v_cvt_pk_bf16_f32 v22, v64, v65
    v_cvt_pk_bf16_f32 v23, v66, v67
    v_lshlrev_b32 v60, 16, v20
    v_and_b32 v61, 0xffff0000, v20
    v_lshlrev_b32 v62, 16, v21
    v_and_b32 v63, 0xffff0000, v21
    v_lshlrev_b32 v64, 16, v22
    v_and_b32 v65, 0xffff0000, v22
    v_lshlrev_b32 v66, 16, v23
    v_and_b32 v67, 0xffff0000, v23
    v_mov_b32 v48, v46
    v_mov_b32 v49, v47
    s_nop 0
    v_permlane16_swap_b32 v46, v48
    v_permlane16_swap_b32 v47, v49
    v_add_f32 v46, v46, v48
    v_add_f32 v47, v47, v49
    v_mov_b32 v48, v46
    v_mov_b32 v49, v47
    s_nop 0
    v_permlane32_swap_b32 v46, v48
    v_permlane32_swap_b32 v47, v49
    v_add_f32 v46, v46, v48
    v_add_f32 v47, v47, v49
    v_mul_f32 v46, 0x3b000000, v46
    v_cvt_pk_bf16_f32 v46, v46, v46
    v_lshlrev_b32 v46, 16, v46
    v_add_f32 v46, 0x3727c5ac, v46
    v_cvt_pk_bf16_f32 v46, v46, v46
    v_lshlrev_b32 v46, 16, v46
    v_sqrt_f32 v46, v46
    s_nop 0
    v_cvt_pk_bf16_f32 v46, v46, v46
    v_lshlrev_b32 v46, 16, v46
    v_rcp_f32 v46, v46
    v_mul_f32 v47, 0x3b000000, v47
    v_cvt_pk_bf16_f32 v47, v47, v47
    v_lshlrev_b32 v47, 16, v47
    v_add_f32 v47, 0x3727c5ac, v47
    v_cvt_pk_bf16_f32 v47, v47, v47
    v_lshlrev_b32 v47, 16, v47
    v_sqrt_f32 v47, v47
    s_nop 0
    v_cvt_pk_bf16_f32 v47, v47, v47
    v_lshlrev_b32 v47, 16, v47
    v_rcp_f32 v47, v47
    s_nop 0
    v_mul_f32 v52, v52, v46
    v_mul_f32 v53, v53, v46
    v_mul_f32 v54, v54, v46
    v_mul_f32 v55, v55, v46
    v_mul_f32 v56, v56, v46
    v_mul_f32 v57, v57, v46
    v_mul_f32 v58, v58, v46
    v_mul_f32 v59, v59, v46
    v_cvt_pk_bf16_f32 v16, v52, v53
    v_cvt_pk_bf16_f32 v17, v54, v55
    v_cvt_pk_bf16_f32 v18, v56, v57
    v_cvt_pk_bf16_f32 v19, v58, v59
    v_mul_f32 v60, v60, v47
    v_mul_f32 v61, v61, v47
    v_mul_f32 v62, v62, v47
    v_mul_f32 v63, v63, v47
    v_mul_f32 v64, v64, v47
    v_mul_f32 v65, v65, v47
    v_mul_f32 v66, v66, v47
    v_mul_f32 v67, v67, v47
    v_cvt_pk_bf16_f32 v20, v60, v61
    v_cvt_pk_bf16_f32 v21, v62, v63
    v_cvt_pk_bf16_f32 v22, v64, v65
    v_cvt_pk_bf16_f32 v23, v66, v67
    ds_write_b64 v12, v[16:17] offset:0
    ds_write_b64 v12, v[18:19] offset:16
    ds_write_b64 v12, v[20:21] offset:1024
    ds_write_b64 v12, v[22:23] offset:1040
    s_waitcnt lgkmcnt(0)
    ds_read_b128 v[96:99], v13 offset:0
    ds_read_b128 v[100:103], v13 offset:64
    ds_read_b128 v[104:107], v13 offset:128
    ds_read_b128 v[108:111], v13 offset:192
    ds_read_b128 v[112:115], v13 offset:256
    ds_read_b128 v[116:119], v13 offset:320
    ds_read_b128 v[120:123], v13 offset:384
    ds_read_b128 v[124:127], v13 offset:448
    v_mov_b32 v16, 0
    s_waitcnt vmcnt(28)
    ds_read_b64_tr_b16 v[24:25], v14 offset:11264
    ds_read_b64_tr_b16 v[26:27], v14 offset:13312
    ds_read_b64_tr_b16 v[28:29], v14 offset:11520
    ds_read_b64_tr_b16 v[30:31], v14 offset:13568
    ds_read_b64_tr_b16 v[32:33], v14 offset:11776
    ds_read_b64_tr_b16 v[34:35], v14 offset:13824
    ds_read_b64_tr_b16 v[36:37], v14 offset:12032
    ds_read_b64_tr_b16 v[38:39], v14 offset:14080
    s_waitcnt lgkmcnt(6)
    v_mfma_f32_16x16x32_bf16 v[144:147], v[24:27], v[96:99], 0
    s_waitcnt lgkmcnt(4)
    v_mfma_f32_16x16x32_bf16 v[148:151], v[28:31], v[96:99], 0
    s_waitcnt lgkmcnt(2)
    v_mfma_f32_16x16x32_bf16 v[152:155], v[32:35], v[96:99], 0
    s_waitcnt lgkmcnt(0)
    v_mfma_f32_16x16x32_bf16 v[156:159], v[36:39], v[96:99], 0
    s_waitcnt vmcnt(24)
    ds_read_b64_tr_b16 v[40:41], v14 offset:15360
    ds_read_b64_tr_b16 v[42:43], v14 offset:17408
    ds_read_b64_tr_b16 v[44:45], v14 offset:15616
    ds_read_b64_tr_b16 v[46:47], v14 offset:17664
    ds_read_b64_tr_b16 v[48:49], v14 offset:15872
    ds_read_b64_tr_b16 v[50:51], v14 offset:17920
    ds_read_b64_tr_b16 v[52:53], v14 offset:16128
    ds_read_b64_tr_b16 v[54:55], v14 offset:18176
    s_waitcnt lgkmcnt(6)
    v_mfma_f32_16x16x32_bf16 v[144:147], v[40:43], v[100:103], v[144:147]
    s_waitcnt lgkmcnt(4)
    v_mfma_f32_16x16x32_bf16 v[148:151], v[44:47], v[100:103], v[148:151]
    s_waitcnt lgkmcnt(2)
    v_mfma_f32_16x16x32_bf16 v[152:155], v[48:51], v[100:103], v[152:155]
    s_waitcnt lgkmcnt(0)
    v_mfma_f32_16x16x32_bf16 v[156:159], v[52:55], v[100:103], v[156:159]
    s_waitcnt vmcnt(20)
    ds_read_b64_tr_b16 v[24:25], v14 offset:19456
    ds_read_b64_tr_b16 v[26:27], v14 offset:21504
    ds_read_b64_tr_b16 v[28:29], v14 offset:19712
    ds_read_b64_tr_b16 v[30:31], v14 offset:21760
    ds_read_b64_tr_b16 v[32:33], v14 offset:19968
    ds_read_b64_tr_b16 v[34:35], v14 offset:22016
    ds_read_b64_tr_b16 v[36:37], v14 offset:20224
    ds_read_b64_tr_b16 v[38:39], v14 offset:22272
    s_waitcnt lgkmcnt(6)
    v_mfma_f32_16x16x32_bf16 v[144:147], v[24:27], v[104:107], v[144:147]
    s_waitcnt lgkmcnt(4)
    v_mfma_f32_16x16x32_bf16 v[148:151], v[28:31], v[104:107], v[148:151]
    s_waitcnt lgkmcnt(2)
    v_mfma_f32_16x16x32_bf16 v[152:155], v[32:35], v[104:107], v[152:155]
    s_waitcnt lgkmcnt(0)
    v_mfma_f32_16x16x32_bf16 v[156:159], v[36:39], v[104:107], v[156:159]
    s_waitcnt vmcnt(16)
    ds_read_b64_tr_b16 v[40:41], v14 offset:23552
    ds_read_b64_tr_b16 v[42:43], v14 offset:25600
    ds_read_b64_tr_b16 v[44:45], v14 offset:23808
    ds_read_b64_tr_b16 v[46:47], v14 offset:25856
    ds_read_b64_tr_b16 v[48:49], v14 offset:24064
    ds_read_b64_tr_b16 v[50:51], v14 offset:26112
    ds_read_b64_tr_b16 v[52:53], v14 offset:24320
    ds_read_b64_tr_b16 v[54:55], v14 offset:26368
    s_waitcnt lgkmcnt(6)
    v_mfma_f32_16x16x32_bf16 v[144:147], v[40:43], v[108:111], v[144:147]
    s_waitcnt lgkmcnt(4)
    v_mfma_f32_16x16x32_bf16 v[148:151], v[44:47], v[108:111], v[148:151]
    s_waitcnt lgkmcnt(2)
    v_mfma_f32_16x16x32_bf16 v[152:155], v[48:51], v[108:111], v[152:155]
    s_waitcnt lgkmcnt(0)
    v_mfma_f32_16x16x32_bf16 v[156:159], v[52:55], v[108:111], v[156:159]
    s_waitcnt vmcnt(12)
    ds_read_b64_tr_b16 v[24:25], v14 offset:27648
    ds_read_b64_tr_b16 v[26:27], v14 offset:29696
    ds_read_b64_tr_b16 v[28:29], v14 offset:27904
    ds_read_b64_tr_b16 v[30:31], v14 offset:29952
    ds_read_b64_tr_b16 v[32:33], v14 offset:28160
    ds_read_b64_tr_b16 v[34:35], v14 offset:30208
    ds_read_b64_tr_b16 v[36:37], v14 offset:28416
    ds_read_b64_tr_b16 v[38:39], v14 offset:30464
    s_waitcnt lgkmcnt(6)
    v_mfma_f32_16x16x32_bf16 v[144:147], v[24:27], v[112:115], v[144:147]
    s_waitcnt lgkmcnt(4)
    v_mfma_f32_16x16x32_bf16 v[148:151], v[28:31], v[112:115], v[148:151]
    s_waitcnt lgkmcnt(2)
    v_mfma_f32_16x16x32_bf16 v[152:155], v[32:35], v[112:115], v[152:155]
    s_waitcnt lgkmcnt(0)
    v_mfma_f32_16x16x32_bf16 v[156:159], v[36:39], v[112:115], v[156:159]
    s_waitcnt vmcnt(8)
    ds_read_b64_tr_b16 v[40:41], v14 offset:31744
    ds_read_b64_tr_b16 v[42:43], v14 offset:33792
    ds_read_b64_tr_b16 v[44:45], v14 offset:32000
    ds_read_b64_tr_b16 v[46:47], v14 offset:34048
    ds_read_b64_tr_b16 v[48:49], v14 offset:32256
    ds_read_b64_tr_b16 v[50:51], v14 offset:34304
    ds_read_b64_tr_b16 v[52:53], v14 offset:32512
    ds_read_b64_tr_b16 v[54:55], v14 offset:34560
    s_waitcnt lgkmcnt(6)
    v_mfma_f32_16x16x32_bf16 v[144:147], v[40:43], v[116:119], v[144:147]
    s_waitcnt lgkmcnt(4)
    v_mfma_f32_16x16x32_bf16 v[148:151], v[44:47], v[116:119], v[148:151]
    s_waitcnt lgkmcnt(2)
    v_mfma_f32_16x16x32_bf16 v[152:155], v[48:51], v[116:119], v[152:155]
    s_waitcnt lgkmcnt(0)
    v_mfma_f32_16x16x32_bf16 v[156:159], v[52:55], v[116:119], v[156:159]
    s_waitcnt vmcnt(4)
    ds_read_b64_tr_b16 v[24:25], v14 offset:35840
    ds_read_b64_tr_b16 v[26:27], v14 offset:37888
    ds_read_b64_tr_b16 v[28:29], v14 offset:36096
    ds_read_b64_tr_b16 v[30:31], v14 offset:38144
    ds_read_b64_tr_b16 v[32:33], v14 offset:36352
    ds_read_b64_tr_b16 v[34:35], v14 offset:38400
    ds_read_b64_tr_b16 v[36:37], v14 offset:36608
    ds_read_b64_tr_b16 v[38:39], v14 offset:38656
    s_waitcnt lgkmcnt(6)
    v_mfma_f32_16x16x32_bf16 v[144:147], v[24:27], v[120:123], v[144:147]
    s_waitcnt lgkmcnt(4)
    v_mfma_f32_16x16x32_bf16 v[148:151], v[28:31], v[120:123], v[148:151]
    s_waitcnt lgkmcnt(2)
    v_mfma_f32_16x16x32_bf16 v[152:155], v[32:35], v[120:123], v[152:155]
    s_waitcnt lgkmcnt(0)
    v_mfma_f32_16x16x32_bf16 v[156:159], v[36:39], v[120:123], v[156:159]
    s_cbranch_execz L_dry1
    v_mov_b32 v18, 10516
    s_mov_b32 s30, 262144
Lw_40:
    ds_read_b32 v17, v18
    s_sub_u32 s30, s30, 1
    s_cbranch_scc1 Lwe_41
    s_waitcnt lgkmcnt(0)
    v_readfirstlane_b32 s24, v17
    s_cmp_eq_u32 s24, 0
    s_cbranch_scc1 Lw_40
Lwe_41:
    s_waitcnt lgkmcnt(0)
L_dry1:
    ds_read_b64 v[58:59], v16 offset:10512
    ds_read_b64 v[62:63], v16 offset:10512
    s_waitcnt lgkmcnt(0)
    ds_write_b32 v16, v58 offset:10520
    s_waitcnt vmcnt(0)
    ds_read_b64_tr_b16 v[40:41], v14 offset:39936
    ds_read_b64_tr_b16 v[42:43], v14 offset:41984
    ds_read_b64_tr_b16 v[44:45], v14 offset:40192
    ds_read_b64_tr_b16 v[46:47], v14 offset:42240
    ds_read_b64_tr_b16 v[48:49], v14 offset:40448
    ds_read_b64_tr_b16 v[50:51], v14 offset:42496
    ds_read_b64_tr_b16 v[52:53], v14 offset:40704
    ds_read_b64_tr_b16 v[54:55], v14 offset:42752
    s_waitcnt lgkmcnt(6)
    v_mfma_f32_16x16x32_bf16 v[144:147], v[40:43], v[124:127], v[144:147]
    s_waitcnt lgkmcnt(4)
    v_mfma_f32_16x16x32_bf16 v[148:151], v[44:47], v[124:127], v[148:151]
    s_waitcnt lgkmcnt(2)
    v_mfma_f32_16x16x32_bf16 v[152:155], v[48:51], v[124:127], v[152:155]
    s_waitcnt lgkmcnt(0)
    v_mfma_f32_16x16x32_bf16 v[156:159], v[52:55], v[124:127], v[156:159]
    s_nop 4
    v_cndmask_b32 v28, v144, v146, s[66:67]
    v_cndmask_b32 v30, v148, v150, s[66:67]
    v_cndmask_b32 v29, v145, v147, s[66:67]
    v_cndmask_b32 v31, v149, v151, s[66:67]
    v_cndmask_b32 v24, v28, v30, s[68:69]
    v_cndmask_b32 v25, v29, v31, s[68:69]
    v_cndmask_b32 v28, v152, v154, s[66:67]
    v_cndmask_b32 v30, v156, v158, s[66:67]
    v_cndmask_b32 v29, v153, v155, s[66:67]
    v_cndmask_b32 v31, v157, v159, s[66:67]
    v_cndmask_b32 v26, v28, v30, s[68:69]
    v_cndmask_b32 v27, v29, v31, s[68:69]
    s_cbranch_execz L_dry2
    s_cmp_eq_u32 s6, 0
    s_cselect_b64 vcc, -1, 0
    s_mov_b32 exec_lo, 0xff00ff
    s_mov_b32 exec_hi, 0xff00ff
    v_cndmask_b32 v56, v24, v26, vcc
    v_cndmask_b32 v57, v25, v27, vcc
    v_cndmask_b32 v60, v26, v24, vcc
    v_cndmask_b32 v61, v27, v25, vcc
    buffer_store_dwordx4 v[56:59], v70, s[8:11], s63 offen
    s_mov_b32 s30, 262144
Lx_42:
    s_cmp_lg_u32 s30, 262140
    s_cbranch_scc1 Lxs_44
    buffer_store_dwordx4 v[56:59], v70, s[8:11], s65 offen sc1
Lxs_44:
    s_and_b32 s24, s30, 7
    s_cmp_eq_u32 s24, 1
    s_cselect_b32 s25, s64, s62
    buffer_load_dwordx4 v[24:27], v70, s[8:11], s25 offen sc1
    s_sub_u32 s30, s30, 1
    s_cbranch_scc1 Lxe_43
    s_waitcnt vmcnt(0)
    v_cmp_ne_u64 vcc, v[26:27], v[58:59]
    s_cmp_lg_u64 vcc, 0
    s_cbranch_scc1 Lx_42
Lxe_43:
    s_waitcnt vmcnt(0)
    v_pk_add_f32 v[60:61], v[60:61], v[24:25]
    v_cvt_pk_bf16_f32 v60, v60, v61
    s_nop 1
    v_mov_b32_dpp v61, v60 quad_perm:[2,3,0,1] row_mask:0xf bank_mask:0xf
    s_mov_b32 exec_lo, 0x330033
    s_mov_b32 exec_hi, 0x330033
    buffer_store_dwordx4 v[60:63], v69, s[8:11], s29 offen sc1
    s_mov_b32 exec_lo, 0xff00ff
    s_mov_b32 exec_hi, 0xff00ff
    buffer_store_dwordx4 v[56:59], v70, s[8:11], s65 offen sc1
    s_mov_b64 exec, -1
    s_branch L_qm1
L_ldr:
    s_sub_u32 s5, s5, 16
    s_lshr_b32 s6, s5, 3
    s_lshl_b32 s24, s4, 4
    s_add_u32 s24, s24, s5
    s_mul_i32 s24, s24, 1152
    s_add_u32 s34, s24, 65536
    s_add_u32 s35, s24, 327680
    s_lshl_b32 s24, s6, 3
    s_add_u32 s24, s24, s4
    s_lshl_b32 s24, s24, 5
    s_and_b32 s25, s5, 7
    s_add_u32 s24, s24, s25
    s_add_u32 s24, s24, 24
    s_lshl_b32 s27, s24, 16
    s_mov_b32 s26, 0
    s_cmp_eq_u32 s3, 9
    s_cbranch_scc1 L_ldv
    v_add_u32 v12, 0, v4
    v_xor_b32 v12, v12, v6
    v_lshlrev_b32 v12, 4, v12
    v_lshl_add_u32 v12, v4, 8, v12
    v_add_u32 v13, 4, v4
    v_xor_b32 v13, v13, v6
    v_lshlrev_b32 v13, 4, v13
    v_lshl_add_u32 v13, v4, 8, v13
    v_add_u32 v14, 8, v4
    v_xor_b32 v14, v14, v6
    v_lshlrev_b32 v14, 4, v14
    v_lshl_add_u32 v14, v4, 8, v14
    v_add_u32 v15, 12, v4
    v_xor_b32 v15, v15, v6
    v_lshlrev_b32 v15, 4, v15
    v_lshl_add_u32 v15, v4, 8, v15
    s_mov_b32 s25, 11264
    s_waitcnt lgkmcnt(0)
    s_mov_b32 s8, s60
    s_mov_b32 s9, s61
    s_mov_b32 s10, 0x200000
    s_mov_b32 s11, 0x00020000
    s_mov_b32 s12, s38
    s_mov_b32 s13, s39
    s_mov_b32 s14, 0x2000000
    s_mov_b32 s15, 0x00020000
L_ldk1:
    s_mov_b32 m0, s25
    s_add_u32 s25, s25, 4096
    buffer_load_dwordx4 v12, s[12:15], s27 offen offset:0 nt lds
    buffer_load_dwordx4 v13, s[12:15], s27 offen offset:1024 nt lds
    buffer_load_dwordx4 v14, s[12:15], s27 offen offset:2048 nt lds
    buffer_load_dwordx4 v15, s[12:15], s27 offen offset:3072 nt lds
    s_add_u32 s27, s27, 4096
    s_add_u32 s26, s26, 1
    s_cmp_lt_u32 s26, 16
    s_cbranch_scc1 L_ldk1
    s_barrier
    s_waitcnt vmcnt(0)
    s_waitcnt lgkmcnt(0)
    v_mov_b32 v17, 10500
    v_mov_b32 v16, 1
    ds_write_b32 v17, v16
    s_waitcnt lgkmcnt(0)
    s_branch L_exit
L_ldv:
    v_mov_b32 v12, 0
    v_mov_b32 v13, 0
    v_mov_b32 v14, 0
    v_mov_b32 v15, 0
    v_mov_b32 v3, 10496
    ds_write_b128 v3, v[12:15]
    ds_write_b128 v3, v[12:15] offset:48
    v_mov_b32 v16, -1
    v_mov_b32 v17, -1
    v_mov_b32 v18, -1
    v_mov_b32 v19, -1
    ds_write_b128 v2, v[16:19] offset:0
    ds_write_b128 v2, v[16:19] offset:2048
    ds_write_b128 v2, v[16:19] offset:3072
    ds_write_b128 v2, v[16:19] offset:4096
    ds_write_b128 v2, v[16:19] offset:5120
    ds_write_b128 v2, v[16:19] offset:6144
    ds_write_b128 v2, v[16:19] offset:7168
    ds_write_b128 v2, v[16:19] offset:8192
    ds_write_b128 v2, v[16:19] offset:9216
    s_mov_b64 exec, 0xffff
    ds_write_b128 v2, v[16:19] offset:10240
    s_mov_b64 exec, -1
    v_lshl_add_u32 v12, v9, 8, v11
    v_xor_b32 v13, 32, v12
    s_waitcnt lgkmcnt(0)
    s_mov_b32 s8, s60
    s_mov_b32 s9, s61
    s_mov_b32 s10, 0x200000
    s_mov_b32 s11, 0x00020000
    s_mov_b32 s16, s40
    s_mov_b32 s17, s41
    s_mov_b32 s18, 0x2000000
    s_mov_b32 s19, 0x00020000
    s_barrier
    buffer_store_dwordx4 v[16:19], v2, s[8:11], s34 offen sc1
    buffer_store_dwordx4 v[16:19], v2, s[8:11], s35 offen sc1
    s_mov_b32 s25, 76800
L_ldv1:
    s_mov_b32 m0, s25
    s_add_u32 s25, s25, 4096
    buffer_load_dwordx4 v12, s[16:19], s27 offen offset:0 nt lds
    buffer_load_dwordx4 v13, s[16:19], s27 offen offset:1024 nt lds
    buffer_load_dwordx4 v12, s[16:19], s27 offen offset:2048 nt lds
    buffer_load_dwordx4 v13, s[16:19], s27 offen offset:3072 nt lds
    s_add_u32 s27, s27, 4096
    s_add_u32 s26, s26, 1
    s_cmp_lt_u32 s26, 16
    s_cbranch_scc1 L_ldv1
    v_mov_b32 v20, 10504
    v_mov_b32 v21, 1
    s_waitcnt vmcnt(56)
    ds_write_b32 v20, v21
    v_mov_b32 v21, 2
    s_waitcnt vmcnt(48)
    ds_write_b32 v20, v21
    v_mov_b32 v21, 3
    s_waitcnt vmcnt(40)
    ds_write_b32 v20, v21
    v_mov_b32 v21, 4
    s_waitcnt vmcnt(32)
    ds_write_b32 v20, v21
    v_mov_b32 v21, 5
    s_waitcnt vmcnt(24)
    ds_write_b32 v20, v21
    v_mov_b32 v21, 6
    s_waitcnt vmcnt(16)
    ds_write_b32 v20, v21
    v_mov_b32 v21, 7
    s_waitcnt vmcnt(8)
    ds_write_b32 v20, v21
    v_mov_b32 v21, 8
    s_waitcnt vmcnt(0)
    ds_write_b32 v20, v21
    s_waitcnt lgkmcnt(0)
    s_branch L_exit
L_dry2:
    s_mov_b64 exec, -1
L_GV:
    s_mul_i32 s32, s4, 7
    s_add_u32 s32, s32, s5
    s_sub_u32 s32, s32, 8
    s_mov_b32 s31, 2
    s_cmp_lt_u32 s5, 8
    s_cselect_b32 s31, 1, s31
    s_cselect_b32 s32, s5, s32
    s_cmp_eq_u32 s5, 15
    s_cselect_b32 s31, 0, s31
    s_waitcnt lgkmcnt(0)
    s_mov_b32 s8, s60
    s_mov_b32 s9, s61
    s_mov_b32 s10, 0x200000
    s_mov_b32 s11, 0x00020000
    s_cmp_ge_u32 s3, 8
    s_cbranch_scc1 L_gld
    s_cmp_lg_u32 s3, 7
    s_cbranch_scc1 L_gv2
    s_cmp_lg_u32 s2, 0
    s_cbranch_scc1 L_gv0
    s_mov_b32 s20, s58
    s_mov_b32 s21, s59
    s_mov_b32 s22, 0x100
    s_mov_b32 s23, 0x00020000
    s_memrealtime s[24:25]
    s_waitcnt lgkmcnt(0)
    s_or_b32 s25, s25, 0x80000000
    v_mov_b32 v14, s24
    v_mov_b32 v15, s25
    v_lshlrev_b32 v12, 6, v0
    s_mov_b64 exec, 15
    buffer_store_dwordx2 v[14:15], v12, s[20:23], 0 offen sc1
    s_mov_b64 exec, -1
L_gv0:
    s_and_b32 s25, s5, 3
    s_lshl_b32 s25, s25, 6
    s_mov_b32 s30, 262144
    s_sleep 10
    s_load_dwordx2 s[100:101], s[58:59], 0
    s_waitcnt lgkmcnt(0)
    s_cmp_lg_u32 s101, 0
    s_cbranch_scc1 L_39
    s_sleep 6
    s_load_dwordx2 s[100:101], s[58:59], 64
    s_waitcnt lgkmcnt(0)
    s_cmp_lg_u32 s101, 0
    s_cbranch_scc1 L_39
    s_sleep 6
    s_load_dwordx2 s[100:101], s[58:59], 128
    s_waitcnt lgkmcnt(0)
    s_cmp_lg_u32 s101, 0
    s_cbranch_scc1 L_39
    s_sleep 6
    s_load_dwordx2 s[100:101], s[58:59], 192
    s_waitcnt lgkmcnt(0)
    s_cmp_lg_u32 s101, 0
    s_cbranch_scc1 L_39
    s_sleep 6
L_38:
    s_load_dwordx2 s[100:101], s[58:59], s25 glc
    s_sub_u32 s30, s30, 1
    s_cbranch_scc1 L_39
    s_waitcnt lgkmcnt(0)
    s_cmp_lg_u32 s101, 0
    s_cbranch_scc1 L_39
    s_sleep 3
    s_branch L_38
L_39:
    s_waitcnt lgkmcnt(0)
    v_mov_b32 v100, s100
    v_mov_b32 v101, s101
    v_and_b32 v104, 0x3ff, v100
    v_bfe_u32 v105, v100, 10, 10
    v_bfe_u32 v106, v100, 20, 10
    v_alignbit_b32 v107, v101, v100, 30
    v_and_b32 v107, 0x3ff, v107
    v_mov_b32 v102, 10512
    ds_write_b64 v102, v[100:101]
    ds_write_b128 v102, v[104:107] offset:16
    s_waitcnt lgkmcnt(0)
    s_mov_b32 s30, 262144
L_echo:
    ds_write_b64 v102, v[100:101]
    ds_read_b32 v103, v102 offset:8
    s_sub_u32 s30, s30, 1
    s_cbranch_scc1 L_gv2
    s_waitcnt lgkmcnt(0)
    v_readfirstlane_b32 s24, v103
    s_sleep 2
    s_cmp_lg_u32 s24, s100
    s_cbranch_scc1 L_echo
L_gv2:
    s_branch L_qm1
L_gld:
    s_and_b32 s29, s3, 1
    v_bfe_u32 v3, v0, 1, 4
    v_lshrrev_b32 v12, 5, v0
    v_lshlrev_b32 v12, 5, v12
    v_lshl_add_u32 v12, v10, 4, v12
    s_cmp_eq_u32 s31, 0
    s_cbranch_scc1 L_exit
    s_cmp_eq_u32 s31, 2
    s_cbranch_scc1 L_gld2
    s_mov_b32 s20, s44
    s_mov_b32 s21, s45
    s_mov_b32 s22, 0x400000
    s_mov_b32 s23, 0x00020000
    v_bfe_u32 v3, v0, 1, 3
    v_lshlrev_b32 v3, 10, v3
    v_lshl_add_u32 v3, v4, 5, v3
    v_lshl_add_u32 v3, v10, 4, v3
    s_lshl_b32 s27, s4, 19
    s_lshl_b32 s25, s29, 18
    s_add_u32 s27, s27, s25
    s_lshl_b32 s25, s32, 7
    s_add_u32 s27, s27, s25
    s_lshl_b32 s28, s29, 15
    s_add_u32 s28, s28, 44032
    s_add_u32 s25, s27, 0
    s_load_dword s64, s[44:45], s25
    s_add_u32 s25, s27, 65536
    s_load_dword s65, s[44:45], s25
    s_add_u32 s25, s27, 131072
    s_load_dword s66, s[44:45], s25
    s_add_u32 s25, s27, 196608
    s_load_dword s67, s[44:45], s25
    s_barrier
    s_mov_b32 s26, 0
L_gld1:
    s_mov_b32 m0, s28
    s_add_u32 s28, s28, 1024
    buffer_load_dwordx4 v3, s[20:23], s27 offen nt lds
    s_add_u32 s27, s27, 8192
    s_mov_b32 m0, s28
    s_add_u32 s28, s28, 1024
    buffer_load_dwordx4 v3, s[20:23], s27 offen nt lds
    s_add_u32 s27, s27, 8192
    s_mov_b32 m0, s28
    s_add_u32 s28, s28, 1024
    buffer_load_dwordx4 v3, s[20:23], s27 offen nt lds
    s_add_u32 s27, s27, 8192
    s_mov_b32 m0, s28
    s_add_u32 s28, s28, 1024
    buffer_load_dwordx4 v3, s[20:23], s27 offen nt lds
    s_add_u32 s27, s27, 8192
    s_add_u32 s26, s26, 1
    s_cmp_lt_u32 s26, 8
    s_cbranch_scc1 L_gld1
    s_branch L_gld5
L_gld2:
    s_cmp_eq_u32 s29, 1
    s_cbranch_scc1 L_gld3
    s_mov_b32 s20, s48
    s_mov_b32 s21, s49
    s_mov_b32 s22, 0x1c0000
    s_mov_b32 s23, 0x00020000
    s_lshl_b32 s27, s32, 6
    s_movk_i32 s25, 3584
    v_mul_lo_u32 v13, v3, s25
    v_add_u32 v13, v13, v12
    s_add_u32 s25, s27, 0
    s_load_dword s64, s[48:49], s25
    s_add_u32 s25, s27, 131072
    s_load_dword s65, s[48:49], s25
    s_add_u32 s25, s27, 262144
    s_load_dword s66, s[48:49], s25
    s_add_u32 s25, s27, 393216
    s_load_dword s67, s[48:49], s25
    s_add_u32 s25, s27, 524288
    s_load_dword s68, s[48:49], s25
    s_add_u32 s25, s27, 655360
    s_load_dword s69, s[48:49], s25
    s_add_u32 s25, s27, 786432
    s_load_dword s70, s[48:49], s25
    s_add_u32 s25, s27, 917504
    s_load_dword s71, s[48:49], s25
    s_add_u32 s25, s27, 1048576
    s_load_dword s72, s[48:49], s25
    s_add_u32 s25, s27, 1179648
    s_load_dword s73, s[48:49], s25
    s_add_u32 s25, s27, 1310720
    s_load_dword s74, s[48:49], s25
    s_add_u32 s25, s27, 1441792
    s_load_dword s75, s[48:49], s25
    s_add_u32 s25, s27, 1572864
    s_load_dword s76, s[48:49], s25
    s_add_u32 s25, s27, 1703936
    s_load_dword s77, s[48:49], s25
    s_barrier
    s_mov_b32 s25, 44032
    s_mov_b32 s26, 0
L_gld4:
    s_mov_b32 m0, s25
    s_add_u32 s25, s25, 1024
    buffer_load_dwordx4 v13, s[20:23], s27 offen nt lds
    s_add_u32 s27, s27, 57344
    s_mov_b32 m0, s25
    s_add_u32 s25, s25, 1024
    buffer_load_dwordx4 v13, s[20:23], s27 offen nt lds
    s_add_u32 s27, s27, 57344
    s_mov_b32 m0, s25
    s_add_u32 s25, s25, 1024
    buffer_load_dwordx4 v13, s[20:23], s27 offen nt lds
    s_add_u32 s27, s27, 57344
    s_mov_b32 m0, s25
    s_add_u32 s25, s25, 1024
    buffer_load_dwordx4 v13, s[20:23], s27 offen nt lds
    s_add_u32 s27, s27, 57344
    s_waitcnt vmcnt(4)
    s_add_u32 s26, s26, 1
    s_cmp_lt_u32 s26, 8
    s_cbranch_scc1 L_gld4
    s_branch L_gld5
L_gld3:
    s_mov_b32 s20, s52
    s_mov_b32 s21, s53
    s_mov_b32 s22, 0x1c0000
    s_mov_b32 s23, 0x00020000
    v_lshl_add_u32 v14, v9, 10, v11
    v_xor_b32 v15, 32, v14
    s_lshl_b32 s27, s32, 15
    s_load_dword s64, s[52:53], s27
    s_load_dword s65, s[50:51], 0
    s_barrier
    s_mov_b32 s25, 76800
    s_mov_b32 s26, 0
L_gld6:
    s_mov_b32 m0, s25
    s_add_u32 s25, s25, 1024
    s_add_u32 s28, s27, 0
    buffer_load_dwordx4 v14, s[20:23], s28 offen nt lds
    s_mov_b32 m0, s25
    s_add_u32 s25, s25, 1024
    s_add_u32 s28, s27, 4096
    buffer_load_dwordx4 v15, s[20:23], s28 offen nt lds
    s_mov_b32 m0, s25
    s_add_u32 s25, s25, 1024
    s_add_u32 s28, s27, 8192
    buffer_load_dwordx4 v14, s[20:23], s28 offen nt lds
    s_mov_b32 m0, s25
    s_add_u32 s25, s25, 1024
    s_add_u32 s28, s27, 12288
    buffer_load_dwordx4 v15, s[20:23], s28 offen nt lds
    s_waitcnt vmcnt(4)
    s_mov_b32 m0, s25
    s_add_u32 s25, s25, 1024
    s_add_u32 s28, s27, 16384
    buffer_load_dwordx4 v14, s[20:23], s28 offen nt lds
    s_mov_b32 m0, s25
    s_add_u32 s25, s25, 1024
    s_add_u32 s28, s27, 20480
    buffer_load_dwordx4 v15, s[20:23], s28 offen nt lds
    s_mov_b32 m0, s25
    s_add_u32 s25, s25, 1024
    s_add_u32 s28, s27, 24576
    buffer_load_dwordx4 v14, s[20:23], s28 offen nt lds
    s_mov_b32 m0, s25
    s_add_u32 s25, s25, 1024
    s_add_u32 s28, s27, 28672
    buffer_load_dwordx4 v15, s[20:23], s28 offen nt lds
    s_waitcnt vmcnt(4)
    s_add_u32 s27, s27, 256
    s_add_u32 s26, s26, 1
    s_cmp_lt_u32 s26, 4
    s_cbranch_scc1 L_gld6
L_gld5:
    s_waitcnt vmcnt(0)
    s_barrier
    s_branch L_exit
L_att:
    s_sub_u32 s5, s5, 16
    s_lshr_b32 s6, s5, 3
    s_lshl_b32 s24, s4, 4
    s_add_u32 s24, s24, s5
    s_mul_i32 s24, s24, 1152
    s_add_u32 s34, s24, 65536
    s_add_u32 s35, s24, 327680
    s_waitcnt lgkmcnt(0)
    s_mov_b32 s8, s60
    s_mov_b32 s9, s61
    s_mov_b32 s10, 0x200000
    s_mov_b32 s11, 0x00020000
    s_mov_b32 s20, s56
    s_mov_b32 s21, s57
    s_mov_b32 s22, 0x800
    s_mov_b32 s23, 0x00020000
    s_mov_b32 s12, s58
    s_mov_b32 s13, s59
    s_mov_b32 s14, 0x100
    s_mov_b32 s15, 0x00020000
    s_lshl_b32 s25, s3, 8
    s_add_u32 s34, s34, s25
    s_add_u32 s35, s35, s25
    v_lshlrev_b32 v80, 6, v6
    v_lshl_add_u32 v80, v4, 4, v80
    s_lshl_b32 s24, s4, 3
    s_lshr_b32 s25, s5, 1
    s_add_u32 s32, s24, s25
    s_and_b32 s31, s5, 1
    s_or_b32 s31, s31, s3
    s_cmp_lg_u32 s31, 0
    s_cbranch_scc1 L_nogsm
    s_mov_b32 s16, s36
    s_mov_b32 s17, s37
    s_mov_b32 s18, 0x800
    s_mov_b32 s19, 0x00020000
    v_and_b32 v84, 3, v0
    v_lshlrev_b32 v84, 3, v84
    s_lshl_b32 s24, s32, 5
    buffer_load_dwordx2 v[72:73], v84, s[16:19], s24 offen
    buffer_load_dwordx2 v[76:77], v84, s[20:23], s24 offen
    s_mov_b32 s16, s54
    s_mov_b32 s17, s55
    s_mov_b32 s18, 0x400
    s_mov_b32 s19, 0x00020000
    s_and_b32 s24, s24, 1023
    buffer_load_dwordx2 v[74:75], v84, s[16:19], s24 offen
L_nogsm:
    s_lshl_b32 s25, s4, 12
    s_lshl_b32 s26, s6, 11
    s_add_u32 s25, s25, s26
    s_lshl_b32 s26, s3, 8
    s_add_u32 s25, s25, s26
    s_add_u32 s26, s8, s25
    s_addc_u32 s27, s9, 0
    s_load_dword s64, s[26:27], 0 glc
    s_load_dword s65, s[26:27], 64 glc
    s_load_dword s66, s[26:27], 128 glc
    s_load_dword s67, s[26:27], 192 glc
    s_lshl_b32 s24, s3, 13
    s_add_u32 s24, s24, 11264
    v_add_u32 v120, 0, v4
    v_xor_b32 v120, v120, v6
    v_lshlrev_b32 v120, 4, v120
    v_lshl_add_u32 v120, v6, 8, v120
    v_add_u32 v120, s24, v120
    v_add_u32 v121, 4, v4
    v_xor_b32 v121, v121, v6
    v_lshlrev_b32 v121, 4, v121
    v_lshl_add_u32 v121, v6, 8, v121
    v_add_u32 v121, s24, v121
    v_add_u32 v122, 8, v4
    v_xor_b32 v122, v122, v6
    v_lshlrev_b32 v122, 4, v122
    v_lshl_add_u32 v122, v6, 8, v122
    v_add_u32 v122, s24, v122
    v_add_u32 v123, 12, v4
    v_xor_b32 v123, v123, v6
    v_lshlrev_b32 v123, 4, v123
    v_lshl_add_u32 v123, v6, 8, v123
    v_add_u32 v123, s24, v123
    s_cmp_lg_u32 s3, 7
    s_cbranch_scc1 L_ntp
    s_and_b32 s25, s5, 3
    s_lshl_b32 s25, s25, 6
    s_mov_b32 s30, 262144
    s_sleep 24
    s_load_dwordx2 s[100:101], s[58:59], 0
    s_waitcnt lgkmcnt(0)
    s_cmp_lg_u32 s101, 0
    s_cbranch_scc1 L_2
    s_sleep 6
    s_load_dwordx2 s[100:101], s[58:59], 64
    s_waitcnt lgkmcnt(0)
    s_cmp_lg_u32 s101, 0
    s_cbranch_scc1 L_2
    s_sleep 6
    s_load_dwordx2 s[100:101], s[58:59], 128
    s_waitcnt lgkmcnt(0)
    s_cmp_lg_u32 s101, 0
    s_cbranch_scc1 L_2
    s_sleep 6
    s_load_dwordx2 s[100:101], s[58:59], 192
    s_waitcnt lgkmcnt(0)
    s_cmp_lg_u32 s101, 0
    s_cbranch_scc1 L_2
    s_sleep 6
L_1:
    s_load_dwordx2 s[100:101], s[58:59], s25 glc
    s_sub_u32 s30, s30, 1
    s_cbranch_scc1 L_2
    s_waitcnt lgkmcnt(0)
    s_cmp_lg_u32 s101, 0
    s_cbranch_scc1 L_2
    s_sleep 3
    s_branch L_1
L_2:
    s_waitcnt lgkmcnt(0)
    v_mov_b32 v100, s100
    v_mov_b32 v101, s101
    v_and_b32 v104, 0x3ff, v100
    v_bfe_u32 v105, v100, 10, 10
    v_bfe_u32 v106, v100, 20, 10
    v_alignbit_b32 v107, v101, v100, 30
    v_and_b32 v107, 0x3ff, v107
    v_mov_b32 v102, 10512
    ds_write_b64 v102, v[100:101]
    ds_write_b128 v102, v[104:107] offset:16
    s_waitcnt lgkmcnt(0)
L_ntp:
    s_barrier
    v_mov_b32 v84, 0
    ds_read_b64 v[86:87], v84 offset:10512
    ds_read_b128 v[124:127], v84 offset:10528
    s_waitcnt lgkmcnt(0)
    v_readfirstlane_b32 s100, v86
    v_readfirstlane_b32 s101, v87
    s_lshl_b32 s24, s3, 7
    v_lshl_add_u32 v85, v0, 2, s24
    v_and_b32 v86, 3, v0
    v_lshlrev_b32 v87, 8, v86
    v_lshl_add_u32 v87, v4, 4, v87
    s_lshl_b32 s24, s3, 2
    v_lshl_add_u32 v106, v0, 5, s24
    v_lshlrev_b32 v107, 5, v86
    v_mov_b32 v104, 10500
    s_mov_b32 s33, 0
    s_mov_b32 s30, 262144
Lq_3:
    s_load_dwordx16 s[36:51], s[26:27], 0 glc
    s_load_dwordx16 s[52:67], s[26:27], 64 glc
    s_load_dwordx16 s[68:83], s[26:27], 128 glc
    s_load_dwordx16 s[84:99], s[26:27], 192 glc
    ds_read_b32 v105, v104
    s_sub_u32 s30, s30, 1
    s_cbranch_scc1 Lqe_4
    s_waitcnt lgkmcnt(0)
    v_readfirstlane_b32 s24, v105
    s_andn2_b32 s24, s24, s33
    s_cbranch_scc0 Lqk_5
    s_mov_b32 s33, 1
    ds_read_b128 v[16:19], v120 offset:0
    ds_read_b128 v[32:35], v120 offset:4096
    ds_read_b128 v[20:23], v121 offset:0
    ds_read_b128 v[36:39], v121 offset:4096
    ds_read_b128 v[24:27], v122 offset:0
    ds_read_b128 v[40:43], v122 offset:4096
    ds_read_b128 v[28:31], v123 offset:0
    ds_read_b128 v[44:47], v123 offset:4096
Lqk_5:
    s_and_b64 s[28:29], s[38:39], s[42:43]
    s_or_b64 s[24:25], s[38:39], s[42:43]
    s_and_b64 s[28:29], s[28:29], s[46:47]
    s_or_b64 s[24:25], s[24:25], s[46:47]
    s_and_b64 s[28:29], s[28:29], s[50:51]
    s_or_b64 s[24:25], s[24:25], s[50:51]
    s_and_b64 s[28:29], s[28:29], s[54:55]
    s_or_b64 s[24:25], s[24:25], s[54:55]
    s_and_b64 s[28:29], s[28:29], s[58:59]
    s_or_b64 s[24:25], s[24:25], s[58:59]
    s_and_b64 s[28:29], s[28:29], s[62:63]
    s_or_b64 s[24:25], s[24:25], s[62:63]
    s_and_b64 s[28:29], s[28:29], s[66:67]
    s_or_b64 s[24:25], s[24:25], s[66:67]
    s_and_b64 s[28:29], s[28:29], s[70:71]
    s_or_b64 s[24:25], s[24:25], s[70:71]
    s_and_b64 s[28:29], s[28:29], s[74:75]
    s_or_b64 s[24:25], s[24:25], s[74:75]
    s_and_b64 s[28:29], s[28:29], s[78:79]
    s_or_b64 s[24:25], s[24:25], s[78:79]
    s_and_b64 s[28:29], s[28:29], s[82:83]
    s_or_b64 s[24:25], s[24:25], s[82:83]
    s_and_b64 s[28:29], s[28:29], s[86:87]
    s_or_b64 s[24:25], s[24:25], s[86:87]
    s_and_b64 s[28:29], s[28:29], s[90:91]
    s_or_b64 s[24:25], s[24:25], s[90:91]
    s_and_b64 s[28:29], s[28:29], s[94:95]
    s_or_b64 s[24:25], s[24:25], s[94:95]
    s_and_b64 s[28:29], s[28:29], s[98:99]
    s_or_b64 s[24:25], s[24:25], s[98:99]
    s_xor_b64 s[28:29], s[28:29], s[100:101]
    s_xor_b64 s[24:25], s[24:25], s[100:101]
    s_or_b64 s[28:29], s[28:29], s[24:25]
    s_cbranch_scc1 Lq_3
Lqe_4:
    s_waitcnt lgkmcnt(0)
    v_writelane_b32 v84, s36, 0
    v_writelane_b32 v84, s37, 1
    v_writelane_b32 v84, s40, 2
    v_writelane_b32 v84, s41, 3
    v_writelane_b32 v84, s44, 4
    v_writelane_b32 v84, s45, 5
    v_writelane_b32 v84, s48, 6
    v_writelane_b32 v84, s49, 7
    v_writelane_b32 v84, s52, 8
    v_writelane_b32 v84, s53, 9
    v_writelane_b32 v84, s56, 10
    v_writelane_b32 v84, s57, 11
    v_writelane_b32 v84, s60, 12
    v_writelane_b32 v84, s61, 13
    v_writelane_b32 v84, s64, 14
    v_writelane_b32 v84, s65, 15
    v_writelane_b32 v84, s68, 16
    v_writelane_b32 v84, s69, 17
    v_writelane_b32 v84, s72, 18
    v_writelane_b32 v84, s73, 19
    v_writelane_b32 v84, s76, 20
    v_writelane_b32 v84, s77, 21
    v_writelane_b32 v84, s80, 22
    v_writelane_b32 v84, s81, 23
    v_writelane_b32 v84, s84, 24
    v_writelane_b32 v84, s85, 25
    v_writelane_b32 v84, s88, 26
    v_writelane_b32 v84, s89, 27
    v_writelane_b32 v84, s92, 28
    v_writelane_b32 v84, s93, 29
    v_writelane_b32 v84, s96, 30
    v_writelane_b32 v84, s97, 31
    s_mov_b32 exec_hi, 0
    ds_write_b32 v85, v84 offset:0
    s_mov_b32 exec_hi, -1
    s_cmp_lg_u32 s33, 0
    s_cbranch_scc1 L_kok
    v_mov_b32 v104, 10500
    s_mov_b32 s30, 262144
Lw_6:
    s_sleep 1
    ds_read_b32 v84, v104
    s_sub_u32 s30, s30, 1
    s_cbranch_scc1 Lwe_7
    s_waitcnt lgkmcnt(0)
    v_readfirstlane_b32 s24, v84
    s_cmp_eq_u32 s24, 0
    s_cbranch_scc1 Lw_6
Lwe_7:
    s_waitcnt lgkmcnt(0)
    ds_read_b128 v[16:19], v120 offset:0
    ds_read_b128 v[32:35], v120 offset:4096
    ds_read_b128 v[20:23], v121 offset:0
    ds_read_b128 v[36:39], v121 offset:4096
    ds_read_b128 v[24:27], v122 offset:0
    ds_read_b128 v[40:43], v122 offset:4096
    ds_read_b128 v[28:31], v123 offset:0
    ds_read_b128 v[44:47], v123 offset:4096
L_kok:
    s_mov_b32 s30, 262144
Lqo_8:
    ds_read_b128 v[48:51], v87 offset:0
    ds_read_b128 v[52:55], v87 offset:64
    ds_read_b128 v[56:59], v87 offset:128
    ds_read_b128 v[60:63], v87 offset:192
    s_sub_u32 s30, s30, 1
    s_cbranch_scc1 Lqoe_9
    s_waitcnt lgkmcnt(0)
    v_max3_u32 v104, v48, v49, v50
    v_max3_u32 v104, v104, v51, v52
    v_max3_u32 v104, v104, v53, v54
    v_max3_u32 v104, v104, v55, v56
    v_max3_u32 v104, v104, v57, v58
    v_max3_u32 v104, v104, v59, v60
    v_max3_u32 v104, v104, v61, v62
    v_max_u32 v104, v104, v63
    v_cmp_eq_u32 vcc, -1, v104
    s_cmp_lg_u64 vcc, 0
    s_cbranch_scc1 Lqo_8
Lqoe_9:
    s_waitcnt lgkmcnt(0)
    v_mfma_f32_16x16x32_bf16 v[64:67], v[16:19], v[48:51], 0
    v_mfma_f32_16x16x32_bf16 v[68:71], v[32:35], v[48:51], 0
    v_mfma_f32_16x16x32_bf16 v[64:67], v[20:23], v[52:55], v[64:67]
    v_mfma_f32_16x16x32_bf16 v[68:71], v[36:39], v[52:55], v[68:71]
    v_mfma_f32_16x16x32_bf16 v[64:67], v[24:27], v[56:59], v[64:67]
    v_mfma_f32_16x16x32_bf16 v[68:71], v[40:43], v[56:59], v[68:71]
    v_mfma_f32_16x16x32_bf16 v[64:67], v[28:31], v[60:63], v[64:67]
    v_mfma_f32_16x16x32_bf16 v[68:71], v[44:47], v[60:63], v[68:71]
    v_mov_b32 v108, 0x3db504f3
    v_mov_b32 v109, 0x3db504f3
    s_mov_b32 s25, 0x3fb8aa3b
    s_nop 4
    v_cvt_pk_bf16_f32 v96, v64, v65
    v_cvt_pk_bf16_f32 v97, v66, v67
    v_cvt_pk_bf16_f32 v98, v68, v69
    v_cvt_pk_bf16_f32 v99, v70, v71
    v_lshlrev_b32 v88, 16, v96
    v_and_b32 v89, 0xffff0000, v96
    v_lshlrev_b32 v90, 16, v97
    v_and_b32 v91, 0xffff0000, v97
    v_lshlrev_b32 v92, 16, v98
    v_and_b32 v93, 0xffff0000, v98
    v_lshlrev_b32 v94, 16, v99
    v_and_b32 v95, 0xffff0000, v99
    v_pk_mul_f32 v[88:89], v[88:89], v[108:109]
    v_pk_mul_f32 v[90:91], v[90:91], v[108:109]
    v_pk_mul_f32 v[92:93], v[92:93], v[108:109]
    v_pk_mul_f32 v[94:95], v[94:95], v[108:109]
    v_cvt_pk_bf16_f32 v96, v88, v89
    v_cvt_pk_bf16_f32 v97, v90, v91
    v_cvt_pk_bf16_f32 v98, v92, v93
    v_cvt_pk_bf16_f32 v99, v94, v95
    v_lshlrev_b32 v88, 16, v96
    v_and_b32 v89, 0xffff0000, v96
    v_lshlrev_b32 v90, 16, v97
    v_and_b32 v91, 0xffff0000, v97
    v_lshlrev_b32 v92, 16, v98
    v_and_b32 v93, 0xffff0000, v98
    v_lshlrev_b32 v94, 16, v99
    v_and_b32 v95, 0xffff0000, v99
    v_max3_f32 v100, v88, v89, v90
    v_max3_f32 v100, v100, v91, v92
    v_max3_f32 v100, v100, v93, v94
    v_max_f32 v100, v100, v95
    v_mov_b32 v104, v100
    s_nop 1
    v_permlane16_swap_b32 v100, v104
    v_max_f32 v100, v100, v104
    v_mov_b32 v104, v100
    s_nop 1
    v_permlane32_swap_b32 v100, v104
    v_max_f32 v100, v100, v104
    s_mov_b64 exec, 15
    ds_write_b32 v106, v100 offset:10240
    s_mov_b64 exec, -1
    v_mul_f32 v88, s25, v88
    v_mul_f32 v89, s25, v89
    v_mul_f32 v90, s25, v90
    v_mul_f32 v91, s25, v91
    v_mul_f32 v92, s25, v92
    v_mul_f32 v93, s25, v93
    v_mul_f32 v94, s25, v94
    v_mul_f32 v95, s25, v95
    s_mov_b32 s30, 262144
Lmx_10:
    ds_read_b128 v[108:111], v107 offset:10240
    ds_read_b128 v[112:115], v107 offset:10256
    s_sub_u32 s30, s30, 1
    s_cbranch_scc1 Lmxe_11
    s_waitcnt lgkmcnt(0)
    v_max3_u32 v104, v108, v109, v110
    v_max3_u32 v104, v104, v111, v112
    v_max3_u32 v104, v104, v113, v114
    v_max_u32 v104, v104, v115
    v_max3_f32 v100, v108, v109, v110
    v_max3_f32 v100, v100, v111, v112
    v_max3_f32 v100, v100, v113, v114
    v_max_f32 v100, v100, v115
    v_cmp_eq_u32 vcc, -1, v104
    s_cmp_lg_u64 vcc, 0
    s_cbranch_scc1 Lmx_10
Lmxe_11:
    s_waitcnt lgkmcnt(0)
    v_mul_f32 v100, s25, v100
    v_sub_f32 v108, v88, v100
    v_sub_f32 v109, v89, v100
    v_sub_f32 v110, v90, v100
    v_sub_f32 v111, v91, v100
    v_sub_f32 v112, v92, v100
    v_sub_f32 v113, v93, v100
    v_sub_f32 v114, v94, v100
    v_sub_f32 v115, v95, v100
    v_exp_f32 v108, v108
    v_exp_f32 v109, v109
    v_exp_f32 v110, v110
    v_exp_f32 v111, v111
    v_exp_f32 v112, v112
    v_exp_f32 v113, v113
    v_exp_f32 v114, v114
    v_exp_f32 v115, v115
    s_lshl_b32 s24, s3, 10
    v_add_u32 v104, s24, v2
    v_cvt_pk_bf16_f32 v96, v108, v109
    v_cvt_pk_bf16_f32 v97, v110, v111
    v_cvt_pk_bf16_f32 v98, v112, v113
    v_cvt_pk_bf16_f32 v99, v114, v115
    ds_write_b128 v104, v[96:99] offset:2048
    v_add_f32 v101, v108, v109
    v_add_f32 v104, v110, v111
    v_add_f32 v105, v112, v113
    v_add_f32 v108, v114, v115
    v_add_f32 v101, v101, v104
    v_add_f32 v108, v108, v105
    v_add_f32 v101, v101, v108
    v_mov_b32 v104, v101
    s_nop 1
    v_permlane16_swap_b32 v101, v104
    v_add_f32 v101, v101, v104
    v_mov_b32 v104, v101
    s_nop 1
    v_permlane32_swap_b32 v101, v104
    v_add_f32 v101, v101, v104
    s_mov_b64 exec, 15
    ds_write_b32 v106, v101 offset:10368
    s_mov_b64 exec, -1
    v_lshlrev_b32 v116, 10, v4
    v_lshl_add_u32 v116, v6, 3, v116
    v_and_b32 v117, 1, v4
    v_lshl_add_u32 v116, v117, 7, v116
    v_xor_b32 v117, 128, v116
    s_lshl_b32 s24, s3, 8
    s_add_u32 s24, s24, 76800
    v_add_u32 v118, s24, v116
    v_add_u32 v119, s24, v117
    s_cmp_gt_u32 s3, 4
    s_cbranch_scc1 L_exit
    v_mov_b32 v85, 10504
    s_mov_b32 s33, 0
    s_cmp_lt_u32 s3, 4
    s_cbranch_scc1 L_pv
    s_cmp_ge_u32 s33, 1
    s_cbranch_scc1 Lvo_13
    s_mov_b32 s30, 262144
Lvp_12:
    ds_read_b32 v84, v85
    s_sub_u32 s30, s30, 1
    s_cbranch_scc1 Lvo_13
    s_waitcnt lgkmcnt(0)
    v_readfirstlane_b32 s33, v84
    s_cmp_lt_u32 s33, 1
    s_cbranch_scc1 Lvp_12
Lvo_13:
    v_mov_b32 v102, s100
    v_mov_b32 v103, s101
    s_mov_b32 s30, 262144
Lls_14:
    ds_read_b128 v[108:111], v107 offset:10368
    ds_read_b128 v[112:115], v107 offset:10384
    s_sub_u32 s30, s30, 1
    s_cbranch_scc1 Llse_15
    s_waitcnt lgkmcnt(0)
    v_max3_u32 v104, v108, v109, v110
    v_max3_u32 v104, v104, v111, v112
    v_max3_u32 v104, v104, v113, v114
    v_max_u32 v104, v104, v115
    v_cmp_eq_u32 vcc, -1, v104
    s_cmp_lg_u64 vcc, 0
    s_cbranch_scc1 Lls_14
Llse_15:
    s_waitcnt lgkmcnt(0)
    v_add_f32 v108, v108, v112
    v_add_f32 v109, v109, v113
    v_add_f32 v110, v110, v114
    v_add_f32 v111, v111, v115
    v_add_f32 v108, v108, v109
    v_add_f32 v110, v110, v111
    v_add_f32 v101, v108, v110
    s_mov_b64 exec, 15
    buffer_store_dwordx4 v[100:103], v2, s[8:11], s34 offen
    buffer_store_dwordx4 v[100:103], v2, s[8:11], s35 offen sc1
    s_branch L_exit
L_pv:
    s_mov_b32 s30, 262144
Lpp_16:
    ds_read_b128 v[128:131], v2 offset:2048
    ds_read_b128 v[132:135], v2 offset:3072
    ds_read_b128 v[136:139], v2 offset:4096
    ds_read_b128 v[140:143], v2 offset:5120
    ds_read_b128 v[144:147], v2 offset:6144
    ds_read_b128 v[148:151], v2 offset:7168
    ds_read_b128 v[152:155], v2 offset:8192
    ds_read_b128 v[156:159], v2 offset:9216
    ds_read_b32 v84, v85
    s_sub_u32 s30, s30, 1
    s_cbranch_scc1 Lppe_17
    s_waitcnt lgkmcnt(0)
    v_max3_u32 v104, v128, v131, v132
    v_max3_u32 v104, v104, v135, v136
    v_max3_u32 v104, v104, v139, v140
    v_max3_u32 v104, v104, v143, v144
    v_max3_u32 v104, v104, v147, v148
    v_max3_u32 v104, v104, v151, v152
    v_max3_u32 v104, v104, v155, v156
    v_max_u32 v104, v104, v159
    v_readfirstlane_b32 s33, v84
    v_cmp_eq_u32 vcc, -1, v104
    s_cmp_lg_u64 vcc, 0
    s_cbranch_scc1 Lpp_16
Lppe_17:
    s_waitcnt lgkmcnt(0)
    s_cmp_ge_u32 s33, 8
    s_cbranch_scc1 L_pvf
    s_cmp_ge_u32 s33, 1
    s_cbranch_scc1 Lvo_19
    s_mov_b32 s30, 262144
Lvp_18:
    ds_read_b32 v84, v85
    s_sub_u32 s30, s30, 1
    s_cbranch_scc1 Lvo_19
    s_waitcnt lgkmcnt(0)
    v_readfirstlane_b32 s33, v84
    s_cmp_lt_u32 s33, 1
    s_cbranch_scc1 Lvp_18
Lvo_19:
    ds_read_b64_tr_b16 v[16:17], v118 offset:0
    ds_read_b64_tr_b16 v[18:19], v118 offset:4096
    ds_read_b64_tr_b16 v[20:21], v119 offset:0
    ds_read_b64_tr_b16 v[22:23], v119 offset:4096
    s_cmp_ge_u32 s33, 2
    s_cbranch_scc1 Lvo_21
    s_mov_b32 s30, 262144
Lvp_20:
    ds_read_b32 v84, v85
    s_sub_u32 s30, s30, 1
    s_cbranch_scc1 Lvo_21
    s_waitcnt lgkmcnt(0)
    v_readfirstlane_b32 s33, v84
    s_cmp_lt_u32 s33, 2
    s_cbranch_scc1 Lvp_20
Lvo_21:
    ds_read_b64_tr_b16 v[24:25], v118 offset:8192
    ds_read_b64_tr_b16 v[26:27], v118 offset:12288
    ds_read_b64_tr_b16 v[28:29], v119 offset:8192
    ds_read_b64_tr_b16 v[30:31], v119 offset:12288
    s_waitcnt lgkmcnt(4)
    v_mfma_f32_16x16x32_bf16 v[64:67], v[16:19], v[128:131], 0
    v_mfma_f32_16x16x32_bf16 v[68:71], v[20:23], v[128:131], 0
    s_cmp_ge_u32 s33, 3
    s_cbranch_scc1 Lvo_23
    s_mov_b32 s30, 262144
Lvp_22:
    ds_read_b32 v84, v85
    s_sub_u32 s30, s30, 1
    s_cbranch_scc1 Lvo_23
    s_waitcnt lgkmcnt(0)
    v_readfirstlane_b32 s33, v84
    s_cmp_lt_u32 s33, 3
    s_cbranch_scc1 Lvp_22
Lvo_23:
    ds_read_b64_tr_b16 v[32:33], v118 offset:16384
    ds_read_b64_tr_b16 v[34:35], v118 offset:20480
    ds_read_b64_tr_b16 v[36:37], v119 offset:16384
    ds_read_b64_tr_b16 v[38:39], v119 offset:20480
    s_waitcnt lgkmcnt(4)
    v_mfma_f32_16x16x32_bf16 v[64:67], v[24:27], v[132:135], v[64:67]
    v_mfma_f32_16x16x32_bf16 v[68:71], v[28:31], v[132:135], v[68:71]
    s_cmp_ge_u32 s33, 4
    s_cbranch_scc1 Lvo_25
    s_mov_b32 s30, 262144
Lvp_24:
    ds_read_b32 v84, v85
    s_sub_u32 s30, s30, 1
    s_cbranch_scc1 Lvo_25
    s_waitcnt lgkmcnt(0)
    v_readfirstlane_b32 s33, v84
    s_cmp_lt_u32 s33, 4
    s_cbranch_scc1 Lvp_24
Lvo_25:
    ds_read_b64_tr_b16 v[40:41], v118 offset:24576
    ds_read_b64_tr_b16 v[42:43], v118 offset:28672
    ds_read_b64_tr_b16 v[44:45], v119 offset:24576
    ds_read_b64_tr_b16 v[46:47], v119 offset:28672
    s_waitcnt lgkmcnt(4)
    v_mfma_f32_16x16x32_bf16 v[64:67], v[32:35], v[136:139], v[64:67]
    v_mfma_f32_16x16x32_bf16 v[68:71], v[36:39], v[136:139], v[68:71]
    s_cmp_ge_u32 s33, 5
    s_cbranch_scc1 Lvo_27
    s_mov_b32 s30, 262144
Lvp_26:
    ds_read_b32 v84, v85
    s_sub_u32 s30, s30, 1
    s_cbranch_scc1 Lvo_27
    s_waitcnt lgkmcnt(0)
    v_readfirstlane_b32 s33, v84
    s_cmp_lt_u32 s33, 5
    s_cbranch_scc1 Lvp_26
Lvo_27:
    ds_read_b64_tr_b16 v[48:49], v118 offset:32768
    ds_read_b64_tr_b16 v[50:51], v118 offset:36864
    ds_read_b64_tr_b16 v[52:53], v119 offset:32768
    ds_read_b64_tr_b16 v[54:55], v119 offset:36864
    s_waitcnt lgkmcnt(4)
    v_mfma_f32_16x16x32_bf16 v[64:67], v[40:43], v[140:143], v[64:67]
    v_mfma_f32_16x16x32_bf16 v[68:71], v[44:47], v[140:143], v[68:71]
    s_cmp_ge_u32 s33, 6
    s_cbranch_scc1 Lvo_29
    s_mov_b32 s30, 262144
Lvp_28:
    ds_read_b32 v84, v85
    s_sub_u32 s30, s30, 1
    s_cbranch_scc1 Lvo_29
    s_waitcnt lgkmcnt(0)
    v_readfirstlane_b32 s33, v84
    s_cmp_lt_u32 s33, 6
    s_cbranch_scc1 Lvp_28
Lvo_29:
    ds_read_b64_tr_b16 v[56:57], v118 offset:40960
    ds_read_b64_tr_b16 v[58:59], v118 offset:45056
    ds_read_b64_tr_b16 v[60:61], v119 offset:40960
    ds_read_b64_tr_b16 v[62:63], v119 offset:45056
    s_waitcnt lgkmcnt(4)
    v_mfma_f32_16x16x32_bf16 v[64:67], v[48:51], v[144:147], v[64:67]
    v_mfma_f32_16x16x32_bf16 v[68:71], v[52:55], v[144:147], v[68:71]
    s_cmp_ge_u32 s33, 7
    s_cbranch_scc1 Lvo_31
    s_mov_b32 s30, 262144
Lvp_30:
    ds_read_b32 v84, v85
    s_sub_u32 s30, s30, 1
    s_cbranch_scc1 Lvo_31
    s_waitcnt lgkmcnt(0)
    v_readfirstlane_b32 s33, v84
    s_cmp_lt_u32 s33, 7
    s_cbranch_scc1 Lvp_30
Lvo_31:
    ds_read_b64_tr_b16 v[16:17], v118 offset:49152
    ds_read_b64_tr_b16 v[18:19], v118 offset:53248
    ds_read_b64_tr_b16 v[20:21], v119 offset:49152
    ds_read_b64_tr_b16 v[22:23], v119 offset:53248
    s_waitcnt lgkmcnt(4)
    v_mfma_f32_16x16x32_bf16 v[64:67], v[56:59], v[148:151], v[64:67]
    v_mfma_f32_16x16x32_bf16 v[68:71], v[60:63], v[148:151], v[68:71]
    s_cmp_ge_u32 s33, 8
    s_cbranch_scc1 Lvo_33
    s_mov_b32 s30, 262144
Lvp_32:
    ds_read_b32 v84, v85
    s_sub_u32 s30, s30, 1
    s_cbranch_scc1 Lvo_33
    s_waitcnt lgkmcnt(0)
    v_readfirstlane_b32 s33, v84
    s_cmp_lt_u32 s33, 8
    s_cbranch_scc1 Lvp_32
Lvo_33:
    ds_read_b64_tr_b16 v[24:25], v118 offset:57344
    ds_read_b64_tr_b16 v[26:27], v118 offset:61440
    ds_read_b64_tr_b16 v[28:29], v119 offset:57344
    ds_read_b64_tr_b16 v[30:31], v119 offset:61440
    s_waitcnt lgkmcnt(4)
    v_mfma_f32_16x16x32_bf16 v[64:67], v[16:19], v[152:155], v[64:67]
    v_mfma_f32_16x16x32_bf16 v[68:71], v[20:23], v[152:155], v[68:71]
    s_waitcnt lgkmcnt(0)
    v_mfma_f32_16x16x32_bf16 v[64:67], v[24:27], v[156:159], v[64:67]
    v_mfma_f32_16x16x32_bf16 v[68:71], v[28:31], v[156:159], v[68:71]
    s_branch L_pve
L_pvf:
    ds_read_b64_tr_b16 v[16:17], v118 offset:0
    ds_read_b64_tr_b16 v[18:19], v118 offset:4096
    ds_read_b64_tr_b16 v[20:21], v119 offset:0
    ds_read_b64_tr_b16 v[22:23], v119 offset:4096
    ds_read_b64_tr_b16 v[24:25], v118 offset:8192
    ds_read_b64_tr_b16 v[26:27], v118 offset:12288
    ds_read_b64_tr_b16 v[28:29], v119 offset:8192
    ds_read_b64_tr_b16 v[30:31], v119 offset:12288
    ds_read_b64_tr_b16 v[32:33], v118 offset:16384
    ds_read_b64_tr_b16 v[34:35], v118 offset:20480
    ds_read_b64_tr_b16 v[36:37], v119 offset:16384
    ds_read_b64_tr_b16 v[38:39], v119 offset:20480
    s_waitcnt lgkmcnt(8)
    v_mfma_f32_16x16x32_bf16 v[64:67], v[16:19], v[128:131], 0
    v_mfma_f32_16x16x32_bf16 v[68:71], v[20:23], v[128:131], 0
    ds_read_b64_tr_b16 v[40:41], v118 offset:24576
    ds_read_b64_tr_b16 v[42:43], v118 offset:28672
    ds_read_b64_tr_b16 v[44:45], v119 offset:24576
    ds_read_b64_tr_b16 v[46:47], v119 offset:28672
    s_waitcnt lgkmcnt(8)
    v_mfma_f32_16x16x32_bf16 v[64:67], v[24:27], v[132:135], v[64:67]
    v_mfma_f32_16x16x32_bf16 v[68:71], v[28:31], v[132:135], v[68:71]
    ds_read_b64_tr_b16 v[48:49], v118 offset:32768
    ds_read_b64_tr_b16 v[50:51], v118 offset:36864
    ds_read_b64_tr_b16 v[52:53], v119 offset:32768
    ds_read_b64_tr_b16 v[54:55], v119 offset:36864
    s_waitcnt lgkmcnt(8)
    v_mfma_f32_16x16x32_bf16 v[64:67], v[32:35], v[136:139], v[64:67]
    v_mfma_f32_16x16x32_bf16 v[68:71], v[36:39], v[136:139], v[68:71]
    ds_read_b64_tr_b16 v[56:57], v118 offset:40960
    ds_read_b64_tr_b16 v[58:59], v118 offset:45056
    ds_read_b64_tr_b16 v[60:61], v119 offset:40960
    ds_read_b64_tr_b16 v[62:63], v119 offset:45056
    s_waitcnt lgkmcnt(8)
    v_mfma_f32_16x16x32_bf16 v[64:67], v[40:43], v[140:143], v[64:67]
    v_mfma_f32_16x16x32_bf16 v[68:71], v[44:47], v[140:143], v[68:71]
    ds_read_b64_tr_b16 v[16:17], v118 offset:49152
    ds_read_b64_tr_b16 v[18:19], v118 offset:53248
    ds_read_b64_tr_b16 v[20:21], v119 offset:49152
    ds_read_b64_tr_b16 v[22:23], v119 offset:53248
    s_waitcnt lgkmcnt(8)
    v_mfma_f32_16x16x32_bf16 v[64:67], v[48:51], v[144:147], v[64:67]
    v_mfma_f32_16x16x32_bf16 v[68:71], v[52:55], v[144:147], v[68:71]
    ds_read_b64_tr_b16 v[24:25], v118 offset:57344
    ds_read_b64_tr_b16 v[26:27], v118 offset:61440
    ds_read_b64_tr_b16 v[28:29], v119 offset:57344
    ds_read_b64_tr_b16 v[30:31], v119 offset:61440
    s_waitcnt lgkmcnt(8)
    v_mfma_f32_16x16x32_bf16 v[64:67], v[56:59], v[148:151], v[64:67]
    v_mfma_f32_16x16x32_bf16 v[68:71], v[60:63], v[148:151], v[68:71]
    s_waitcnt lgkmcnt(4)
    v_mfma_f32_16x16x32_bf16 v[64:67], v[16:19], v[152:155], v[64:67]
    v_mfma_f32_16x16x32_bf16 v[68:71], v[20:23], v[152:155], v[68:71]
    s_waitcnt lgkmcnt(0)
    v_mfma_f32_16x16x32_bf16 v[64:67], v[24:27], v[156:159], v[64:67]
    v_mfma_f32_16x16x32_bf16 v[68:71], v[28:31], v[156:159], v[68:71]
L_pve:
    s_nop 6
    v_cvt_pk_bf16_f32 v96, v64, v65
    v_cvt_pk_bf16_f32 v97, v66, v67
    v_cvt_pk_bf16_f32 v98, v68, v69
    v_cvt_pk_bf16_f32 v99, v70, v71
    s_mov_b32 exec_lo, 0xf000f
    s_mov_b32 exec_hi, 0xf000f
    buffer_store_dwordx4 v[96:99], v80, s[8:11], s34 offen
    buffer_store_dwordx4 v[96:99], v80, s[8:11], s35 offen sc1
    s_mov_b64 exec, -1
    s_cmp_lg_u32 s31, 0
    s_cbranch_scc1 L_exit
    s_lshl_b32 s26, s32, 6
    s_add_u32 s27, s26, 688128
    s_add_u32 s26, s26, 720896
    v_lshrrev_b32 v106, 2, v0
    v_and_b32 v107, 3, v0
    v_lshlrev_b32 v104, 12, v106
    v_lshl_add_u32 v104, v107, 4, v104
    s_movk_i32 s24, 4224
    v_mul_lo_u32 v106, v106, s24
    v_lshl_add_u32 v106, v107, 4, v106
    s_add_u32 s41, s26, 67584
    s_add_u32 s42, s26, 135168
    s_add_u32 s43, s26, 202752
    s_mov_b64 exec, 0
L_kret:
    s_cbranch_execz L_sk1
    s_mov_b32 exec_hi, 0
    s_mov_b32 s30, 262144
Lt_34:
    buffer_load_dwordx4 v[128:131], v104, s[8:11], s27 offen sc1
    s_sub_u32 s30, s30, 1
    s_cbranch_scc1 Lte_35
    s_waitcnt vmcnt(0)
    v_xor_b32 v128, v128, v124
    v_xor_b32 v129, v129, v125
    v_xor_b32 v130, v130, v126
    v_xor_b32 v131, v131, v127
    v_or3_b32 v84, v128, v129, v130
    v_or_b32 v84, v84, v131
    v_and_b32 v84, v5, v84
    v_cmp_ne_u32 vcc, 0, v84
    s_cmp_lg_u64 vcc, 0
    s_cbranch_scc1 Lt_34
Lte_35:
    s_waitcnt vmcnt(0)
    s_mov_b64 exec, -1
L_sk1:
    s_cmp_lg_u32 s32, 0
    s_cbranch_scc1 L_gnz
    v_mov_b32 v84, 0
    v_mov_b32 v85, 0
    v_lshlrev_b32 v86, 6, v0
    s_cbranch_execz L_sk2
    s_mov_b64 exec, 15
    buffer_store_dwordx2 v[84:85], v86, s[12:15], 0 offen sc1
    s_mov_b64 exec, -1
L_sk2:
L_gnz:
    s_nop 0
    v_add_f32_dpp v128, v128, v128 row_ror:4 row_mask:0xf bank_mask:0xf
    v_add_f32_dpp v129, v129, v129 row_ror:4 row_mask:0xf bank_mask:0xf
    v_add_f32_dpp v130, v130, v130 row_ror:4 row_mask:0xf bank_mask:0xf
    v_add_f32_dpp v131, v131, v131 row_ror:4 row_mask:0xf bank_mask:0xf
    v_add_f32_dpp v128, v128, v128 row_ror:8 row_mask:0xf bank_mask:0xf
    v_add_f32_dpp v129, v129, v129 row_ror:8 row_mask:0xf bank_mask:0xf
    v_add_f32_dpp v130, v130, v130 row_ror:8 row_mask:0xf bank_mask:0xf
    v_add_f32_dpp v131, v131, v131 row_ror:8 row_mask:0xf bank_mask:0xf
    v_mov_b32 v132, v128
    v_mov_b32 v133, v129
    v_mov_b32 v134, v130
    v_mov_b32 v135, v131
    v_permlane16_swap_b32 v128, v132
    v_permlane16_swap_b32 v129, v133
    v_permlane16_swap_b32 v130, v134
    v_permlane16_swap_b32 v131, v135
    v_add_f32 v128, v128, v132
    v_add_f32 v129, v129, v133
    v_add_f32 v130, v130, v134
    v_add_f32 v131, v131, v135
    v_cvt_pk_bf16_f32 v144, v128, v129
    v_cvt_pk_bf16_f32 v145, v130, v131
    v_lshlrev_b32 v128, 16, v144
    v_and_b32 v129, 0xffff0000, v144
    v_lshlrev_b32 v130, 16, v145
    v_and_b32 v131, 0xffff0000, v145
    v_lshlrev_b32 v136, 16, v72
    v_and_b32 v137, 0xffff0000, v72
    v_lshlrev_b32 v138, 16, v73
    v_and_b32 v139, 0xffff0000, v73
    v_add_f32 v136, v136, v128
    v_add_f32 v137, v137, v129
    v_add_f32 v138, v138, v130
    v_add_f32 v139, v139, v131
    v_cvt_pk_bf16_f32 v144, v136, v137
    v_cvt_pk_bf16_f32 v145, v138, v139
    v_lshlrev_b32 v136, 16, v144
    v_and_b32 v137, 0xffff0000, v144
    v_lshlrev_b32 v138, 16, v145
    v_and_b32 v139, 0xffff0000, v145
    v_lshlrev_b32 v148, 16, v74
    v_and_b32 v149, 0xffff0000, v74
    v_lshlrev_b32 v150, 16, v75
    v_and_b32 v151, 0xffff0000, v75
    s_mov_b32 s30, 262144
Lt_36:
    v_mov_b32 v28, v124
    v_mov_b32 v29, v125
    v_mov_b32 v30, v126
    v_mov_b32 v31, v127
    s_cbranch_execz L_sk3
    buffer_load_dwordx4 v[16:19], v106, s[8:11], s26 offen sc1
    buffer_load_dwordx4 v[20:23], v106, s[8:11], s41 offen sc1
    buffer_load_dwordx4 v[24:27], v106, s[8:11], s42 offen sc1
    s_mov_b32 exec_hi, 0
    buffer_load_dwordx4 v[28:31], v106, s[8:11], s43 offen sc1
    s_mov_b32 exec_hi, -1
L_sk3:
    s_sub_u32 s30, s30, 1
    s_cbranch_scc1 Lte_37
    s_waitcnt vmcnt(0)
    v_xor_b32 v16, v16, v124
    v_xor_b32 v17, v17, v125
    v_xor_b32 v18, v18, v126
    v_xor_b32 v19, v19, v127
    v_xor_b32 v20, v20, v124
    v_xor_b32 v21, v21, v125
    v_xor_b32 v22, v22, v126
    v_xor_b32 v23, v23, v127
    v_xor_b32 v24, v24, v124
    v_xor_b32 v25, v25, v125
    v_xor_b32 v26, v26, v126
    v_xor_b32 v27, v27, v127
    v_xor_b32 v28, v28, v124
    v_xor_b32 v29, v29, v125
    v_xor_b32 v30, v30, v126
    v_xor_b32 v31, v31, v127
    v_or3_b32 v84, v16, v17, v18
    v_or3_b32 v84, v84, v19, v20
    v_or3_b32 v84, v84, v21, v22
    v_or3_b32 v84, v84, v23, v24
    v_or3_b32 v84, v84, v25, v26
    v_or3_b32 v84, v84, v27, v28
    v_or3_b32 v84, v84, v29, v30
    v_or_b32 v84, v84, v31
    v_and_b32 v84, v5, v84
    v_cmp_ne_u32 vcc, 0, v84
    s_cmp_lg_u64 vcc, 0
    s_cbranch_scc1 Lt_36
Lte_37:
    s_waitcnt vmcnt(0)
    v_add_f32 v16, v16, v20
    v_add_f32 v24, v24, v28
    v_add_f32 v17, v17, v21
    v_add_f32 v25, v25, v29
    v_add_f32 v18, v18, v22
    v_add_f32 v26, v26, v30
    v_add_f32 v19, v19, v23
    v_add_f32 v27, v27, v31
    v_add_f32 v16, v16, v24
    v_add_f32 v17, v17, v25
    v_add_f32 v18, v18, v26
    v_add_f32 v19, v19, v27
    v_add_f32_dpp v16, v16, v16 row_ror:4 row_mask:0xf bank_mask:0xf
    v_add_f32_dpp v17, v17, v17 row_ror:4 row_mask:0xf bank_mask:0xf
    v_add_f32_dpp v18, v18, v18 row_ror:4 row_mask:0xf bank_mask:0xf
    v_add_f32_dpp v19, v19, v19 row_ror:4 row_mask:0xf bank_mask:0xf
    v_add_f32_dpp v16, v16, v16 row_ror:8 row_mask:0xf bank_mask:0xf
    v_add_f32_dpp v17, v17, v17 row_ror:8 row_mask:0xf bank_mask:0xf
    v_add_f32_dpp v18, v18, v18 row_ror:8 row_mask:0xf bank_mask:0xf
    v_add_f32_dpp v19, v19, v19 row_ror:8 row_mask:0xf bank_mask:0xf
    v_mov_b32 v20, v16
    v_mov_b32 v21, v17
    v_mov_b32 v22, v18
    v_mov_b32 v23, v19
    v_permlane16_swap_b32 v16, v20
    v_permlane16_swap_b32 v17, v21
    v_permlane16_swap_b32 v18, v22
    v_permlane16_swap_b32 v19, v23
    v_add_f32 v16, v16, v20
    v_add_f32 v17, v17, v21
    v_add_f32 v18, v18, v22
    v_add_f32 v19, v19, v23
    v_mov_b32 v20, v16
    v_mov_b32 v21, v17
    v_mov_b32 v22, v18
    v_mov_b32 v23, v19
    v_permlane32_swap_b32 v16, v20
    v_permlane32_swap_b32 v17, v21
    v_permlane32_swap_b32 v18, v22
    v_permlane32_swap_b32 v19, v23
    v_add_f32 v16, v16, v20
    v_add_f32 v17, v17, v21
    v_add_f32 v18, v18, v22
    v_add_f32 v19, v19, v23
    v_cvt_pk_bf16_f32 v144, v16, v17
    v_cvt_pk_bf16_f32 v145, v18, v19
    v_lshlrev_b32 v16, 16, v144
    v_and_b32 v17, 0xffff0000, v144
    v_lshlrev_b32 v18, 16, v145
    v_and_b32 v19, 0xffff0000, v145
    v_add_f32 v16, v16, v148
    v_add_f32 v17, v17, v149
    v_add_f32 v18, v18, v150
    v_add_f32 v19, v19, v151
    v_cvt_pk_bf16_f32 v144, v16, v17
    v_cvt_pk_bf16_f32 v145, v18, v19
    v_lshlrev_b32 v16, 16, v144
    v_and_b32 v17, 0xffff0000, v144
    v_lshlrev_b32 v18, 16, v145
    v_and_b32 v19, 0xffff0000, v145
    v_add_f32 v16, v16, v136
    v_add_f32 v17, v17, v137
    v_add_f32 v18, v18, v138
    v_add_f32 v19, v19, v139
    v_cvt_pk_bf16_f32 v144, v16, v17
    v_cvt_pk_bf16_f32 v145, v18, v19
    s_lshl_b32 s28, s32, 5
    v_lshlrev_b32 v3, 3, v0
    s_cbranch_execz L_sk4
    s_mov_b64 exec, 15
    buffer_store_dwordx2 v[144:145], v3, s[20:23], s28 offen
L_sk4:
    s_branch L_exit_1
L_qm1:
    s_cmp_eq_u32 s31, 0
    s_cbranch_scc1 L_exit
    s_barrier
    v_mov_b32 v84, 0
    ds_read_b64 v[106:107], v84 offset:10512
    ds_read_b128 v[124:127], v84 offset:10528
    s_cmp_eq_u32 s31, 2
    s_cbranch_scc1 L_F
    s_lshl_b32 s25, s4, 4
    s_lshl_b32 s26, s3, 1
    s_add_u32 s25, s25, s26
    s_mul_i32 s25, s25, 1152
    s_add_u32 s34, s25, 65536
    s_add_u32 s35, s25, 327680
    v_lshrrev_b32 v120, 2, v0
    s_movk_i32 s26, 1152
    v_mul_lo_u32 v120, v120, s26
    v_and_b32 v121, 3, v0
    v_lshl_add_u32 v120, v121, 4, v120
    s_mul_i32 s26, s3, 2080
    s_add_u32 s26, s26, 109568
    v_add_u32 v121, s26, v2
    s_lshl_b32 s26, s3, 7
    v_add_u32 v122, s26, v2
    s_and_b32 s28, s3, 3
    s_lshr_b32 s29, s3, 2
    s_movk_i32 s26, 1040
    v_mul_lo_u32 v123, v6, s26
    v_lshl_add_u32 v123, v4, 4, v123
    s_lshl_b32 s26, s28, 6
    s_add_u32 s26, s26, 109568
    v_add_u32 v123, s26, v123
    v_lshlrev_b32 v86, 6, v6
    s_lshl_b32 s26, s28, 4
    v_add_u32 v86, s26, v86
    s_lshl_b32 s26, s28, 9
    s_lshl_b32 s27, s29, 8
    s_add_u32 s26, s26, s27
    v_lshl_add_u32 v87, v0, 2, s26
    v_lshrrev_b32 v104, 5, v0
    v_lshlrev_b32 v104, 10, v104
    v_and_b32 v105, 31, v0
    v_lshl_add_u32 v104, v105, 3, v104
    s_lshl_b32 s26, s28, 14
    s_lshl_b32 s27, s29, 9
    s_add_u32 s26, s26, s27
    s_add_u32 s26, s26, 44032
    v_add_u32 v104, s26, v104
    v_mul_u32_u24 v116, 80, v4
    v_bfe_u32 v117, v0, 3, 1
    v_lshlrev_b32 v117, 8, v117
    v_lshl_add_u32 v117, v4, 7, v117
    v_and_b32 v118, 7, v0
    v_lshl_add_u32 v117, v118, 4, v117
    v_lshlrev_b32 v118, 11, v4
    v_lshl_add_u32 v118, v6, 4, v118
    s_lshl_b32 s33, s4, 12
    s_lshl_b32 s25, s32, 8
    s_add_u32 s33, s33, s25
    s_add_u32 s33, s33, 688128
    s_waitcnt lgkmcnt(0)
    s_mov_b64 exec, 0
    s_branch L_edry
L_eret:
    s_waitcnt vmcnt(0) lgkmcnt(0)
    s_barrier
L_edry:
    ds_read_b64_tr_b16 v[16:17], v104 offset:0
    ds_read_b64_tr_b16 v[18:19], v104 offset:2048
    ds_read_b64_tr_b16 v[20:21], v104 offset:256
    ds_read_b64_tr_b16 v[22:23], v104 offset:2304
    ds_read_b64_tr_b16 v[24:25], v104 offset:4096
    ds_read_b64_tr_b16 v[26:27], v104 offset:6144
    ds_read_b64_tr_b16 v[28:29], v104 offset:4352
    ds_read_b64_tr_b16 v[30:31], v104 offset:6400
    ds_read_b64_tr_b16 v[32:33], v104 offset:8192
    ds_read_b64_tr_b16 v[34:35], v104 offset:10240
    ds_read_b64_tr_b16 v[36:37], v104 offset:8448
    ds_read_b64_tr_b16 v[38:39], v104 offset:10496
    ds_read_b64_tr_b16 v[40:41], v104 offset:12288
    ds_read_b64_tr_b16 v[42:43], v104 offset:14336
    ds_read_b64_tr_b16 v[44:45], v104 offset:12544
    ds_read_b64_tr_b16 v[46:47], v104 offset:14592
    s_mov_b32 s30, 262144
Le_45:
    s_and_b32 s24, s30, 15
    s_cmp_eq_u32 s24, 1
    s_cselect_b32 s25, s35, s34
    v_mov_b32 v138, v106
    v_mov_b32 v139, v107
    s_cbranch_execz L_sk5
    s_mov_b64 exec, 0xff
    buffer_load_dwordx4 v[136:139], v120, s[8:11], s25 offen offset:1024 sc1
    s_mov_b64 exec, -1
    buffer_load_dwordx4 v[128:131], v2, s[8:11], s25 offen offset:0 sc1
    buffer_load_dwordx4 v[132:135], v2, s[8:11], s25 offen offset:1152 sc1
L_sk5:
    s_sub_u32 s30, s30, 1
    s_cbranch_scc1 Lee_46
    s_waitcnt vmcnt(0)
    v_max3_u32 v104, v128, v129, v130
    v_max3_u32 v104, v104, v131, v132
    v_max3_u32 v104, v104, v133, v134
    v_max_u32 v104, v104, v135
    v_cmp_eq_u32 vcc, -1, v104
    v_cmp_ne_u64 s[26:27], v[138:139], v[106:107]
    s_or_b64 vcc, vcc, s[26:27]
    s_cbranch_scc1 Le_45
Lee_46:
    s_waitcnt vmcnt(0)
    ds_write_b128 v121, v[128:131] offset:0
    ds_write_b128 v121, v[132:135] offset:1040
    s_cbranch_execz L_sk6
    s_mov_b64 exec, 0xff
    ds_write_b128 v122, v[136:139] offset:8192
    s_mov_b64 exec, -1
L_sk6:
    s_waitcnt lgkmcnt(0)
    s_cbranch_execz L_sk7
    s_barrier
L_sk7:
    ds_read_b64 v[88:89], v86 offset:8192
    ds_read_b128 v[128:131], v123 offset:0
    ds_read_b128 v[132:135], v123 offset:256
    ds_read_b128 v[136:139], v123 offset:512
    ds_read_b128 v[140:143], v123 offset:768
    s_waitcnt lgkmcnt(4)
    v_mov_b32 v92, v88
    s_waitcnt lgkmcnt(3)
    v_mfma_f32_16x16x32_bf16 v[64:67], v[128:131], v[16:19], 0
    s_nop 0
    v_max_f32_dpp v92, v92, v92 quad_perm:[1,0,3,2] row_mask:0xf bank_mask:0xf
    v_mfma_f32_16x16x32_bf16 v[68:71], v[128:131], v[20:23], 0
    s_nop 0
    v_max_f32_dpp v92, v92, v92 quad_perm:[2,3,0,1] row_mask:0xf bank_mask:0xf
    s_waitcnt lgkmcnt(2)
    v_mfma_f32_16x16x32_bf16 v[64:67], v[132:135], v[24:27], v[64:67]
    s_nop 0
    v_max_f32_dpp v92, v92, v92 row_half_mirror row_mask:0xf bank_mask:0xf
    v_mfma_f32_16x16x32_bf16 v[68:71], v[132:135], v[28:31], v[68:71]
    v_sub_f32 v88, v88, v92
    v_exp_f32 v88, v88
    s_nop 0
    v_mul_f32 v92, v88, v89
    s_waitcnt lgkmcnt(1)
    v_mfma_f32_16x16x32_bf16 v[64:67], v[136:139], v[32:35], v[64:67]
    s_nop 0
    v_add_f32_dpp v92, v92, v92 quad_perm:[1,0,3,2] row_mask:0xf bank_mask:0xf
    v_mfma_f32_16x16x32_bf16 v[68:71], v[136:139], v[36:39], v[68:71]
    s_nop 0
    v_add_f32_dpp v92, v92, v92 quad_perm:[2,3,0,1] row_mask:0xf bank_mask:0xf
    s_waitcnt lgkmcnt(0)
    v_mfma_f32_16x16x32_bf16 v[64:67], v[140:143], v[40:43], v[64:67]
    s_nop 0
    v_add_f32_dpp v92, v92, v92 row_half_mirror row_mask:0xf bank_mask:0xf
    v_mfma_f32_16x16x32_bf16 v[68:71], v[140:143], v[44:47], v[68:71]
    v_rcp_f32 v92, v92
    s_nop 0
    v_mul_f32 v88, v88, v92
    ds_bpermute_b32 v108, v116, v88 offset:0
    ds_bpermute_b32 v109, v116, v88 offset:4
    ds_bpermute_b32 v110, v116, v88 offset:8
    ds_bpermute_b32 v111, v116, v88 offset:12
    s_waitcnt lgkmcnt(0)
    v_mul_f32 v64, v64, v108
    v_mul_f32 v66, v66, v110
    v_fmac_f32 v64, v65, v109
    v_fmac_f32 v66, v67, v111
    v_mul_f32 v68, v68, v108
    v_mul_f32 v70, v70, v110
    v_fmac_f32 v68, v69, v109
    v_fmac_f32 v70, v71, v111
    v_add_f32 v64, v64, v66
    v_add_f32 v68, v68, v70
    s_nop 1
    v_permlane16_swap_b32 v64, v68
    v_add_f32 v64, v64, v68
    ds_write_b32 v87, v64 offset:6144
    s_waitcnt lgkmcnt(0)
    s_cbranch_execz L_sk8
    s_barrier
L_sk8:
    s_cmp_lg_u32 s3, 0
    s_cbranch_scc1 L_exit_2
    s_cbranch_execz L_sk9
    s_mov_b32 exec_hi, 0
    ds_read_b128 v[128:131], v117 offset:6144
    ds_read_b128 v[132:135], v117 offset:6656
    ds_read_b128 v[136:139], v117 offset:7168
    ds_read_b128 v[140:143], v117 offset:7680
    s_waitcnt lgkmcnt(0)
    v_pk_add_f32 v[128:129], v[128:129], v[132:133]
    v_pk_add_f32 v[136:137], v[136:137], v[140:141]
    v_pk_add_f32 v[130:131], v[130:131], v[134:135]
    v_pk_add_f32 v[138:139], v[138:139], v[142:143]
    v_pk_add_f32 v[128:129], v[128:129], v[136:137]
    v_pk_add_f32 v[130:131], v[130:131], v[138:139]
    v_add_u32 v128, 0x200, v128
    v_add_u32 v129, 0x200, v129
    v_add_u32 v130, 0x200, v130
    v_add_u32 v131, 0x200, v131
    v_bfi_b32 v128, v5, v124, v128
    v_bfi_b32 v129, v5, v125, v129
    v_bfi_b32 v130, v5, v126, v130
    v_bfi_b32 v131, v5, v127, v131
    buffer_store_dwordx4 v[128:131], v118, s[8:11], s33 offen sc1
L_sk9:
    s_branch L_exit_2
L_F:
    s_mov_b32 s12, s36
    s_mov_b32 s13, s37
    s_mov_b32 s14, 0x800
    s_mov_b32 s15, 0x00020000
    v_and_b32 v12, 31, v0
    v_lshlrev_b32 v13, 3, v12
    s_lshl_b32 s24, s3, 8
    buffer_load_dwordx2 v[72:73], v13, s[12:15], s24 offen
    s_mov_b32 s20, s50
    s_mov_b32 s21, s51
    s_mov_b32 s22, 0xe00
    s_mov_b32 s23, 0x00020000
    v_lshlrev_b32 v13, 1, v12
    s_lshl_b32 s24, s32, 6
    buffer_load_ushort v74, v13, s[20:23], s24 offen
    v_lshrrev_b32 v84, 5, v0
    v_lshlrev_b32 v84, 12, v84
    v_lshl_add_u32 v84, v12, 4, v84
    s_lshl_b32 s24, s3, 9
    s_add_u32 s24, s24, 688128
    s_add_u32 s62, s24, 0
    s_add_u32 s63, s24, 8192
    s_add_u32 s64, s24, 16384
    s_add_u32 s65, s24, 24576
    v_lshrrev_b32 v85, 3, v12
    v_lshlrev_b32 v85, 6, v85
    v_and_b32 v13, 3, v0
    v_lshl_add_u32 v85, v13, 4, v85
    v_bfe_u32 v13, v0, 2, 1
    v_lshl_add_u32 v85, v13, 3, v85
    s_lshl_b32 s24, s3, 8
    v_add_u32 v85, s24, v85
    s_lshl_b32 s24, s3, 3
    v_mov_b32 v86, s24
    s_lshr_b32 s24, s3, 2
    s_lshl_b32 s24, s24, 5
    v_mov_b32 v87, s24
    v_mov_b32 v14, -1
    v_mov_b32 v15, -1
    ds_write_b64 v86, v[14:15] offset:8192
    v_lshlrev_b32 v116, 10, v4
    v_lshl_add_u32 v116, v6, 3, v116
    v_and_b32 v117, 1, v4
    v_lshl_add_u32 v116, v117, 7, v116
    v_xor_b32 v117, 128, v116
    s_lshl_b32 s24, s3, 13
    s_add_u32 s25, s24, 76800
    v_add_u32 v118, s25, v116
    v_add_u32 v119, s25, v117
    s_add_u32 s25, s24, 44032
    v_lshl_add_u32 v104, v0, 3, s25
    v_lshlrev_b32 v120, 10, v10
    v_lshl_add_u32 v120, v4, 4, v120
    s_lshl_b32 s24, s3, 8
    v_add_u32 v120, s24, v120
    v_lshlrev_b32 v121, 7, v6
    v_lshl_add_u32 v121, v4, 4, v121
    v_add_u32 v121, s24, v121
    v_lshrrev_b32 v122, 5, v0
    v_lshlrev_b32 v122, 6, v122
    v_bfe_u32 v13, v0, 2, 2
    v_lshl_add_u32 v122, v13, 4, v122
    v_bfe_u32 v13, v0, 4, 1
    v_lshl_add_u32 v122, v13, 3, v122
    v_and_b32 v13, 3, v0
    v_lshl_add_u32 v122, v13, 1, v122
    s_lshl_b32 s25, s3, 7
    s_add_u32 s25, s25, 9216
    v_add_u32 v122, s25, v122
    v_lshlrev_b32 v13, 6, v10
    v_lshl_add_u32 v13, v4, 4, v13
    v_add_u32 v13, s25, v13
    v_mov_b32 v14, 9728
    v_bfe_u32 v15, v0, 1, 3
    v_cmp_eq_u32 vcc, 0, v15
    s_nop 1
    v_cndmask_b32 v108, v14, v13, vcc
    v_cmp_eq_u32 vcc, 1, v15
    s_nop 1
    v_cndmask_b32 v109, v14, v13, vcc
    v_cmp_eq_u32 vcc, 2, v15
    s_nop 1
    v_cndmask_b32 v110, v14, v13, vcc
    v_cmp_eq_u32 vcc, 3, v15
    s_nop 1
    v_cndmask_b32 v111, v14, v13, vcc
    v_cmp_eq_u32 vcc, 4, v15
    s_nop 1
    v_cndmask_b32 v112, v14, v13, vcc
    v_cmp_eq_u32 vcc, 5, v15
    s_nop 1
    v_cndmask_b32 v113, v14, v13, vcc
    v_cmp_eq_u32 vcc, 6, v15
    s_nop 1
    v_cndmask_b32 v114, v14, v13, vcc
    v_cmp_eq_u32 vcc, 7, v15
    s_nop 1
    v_cndmask_b32 v115, v14, v13, vcc
    v_mov_b32 v16, 0
    v_mov_b32 v17, 0
    v_mov_b32 v18, 0
    v_mov_b32 v19, 0
    ds_write_b128 v14, v[16:19]
    v_lshlrev_b32 v123, 11, v10
    v_lshl_add_u32 v123, v15, 6, v123
    v_lshl_add_u32 v123, v4, 4, v123
    s_mul_i32 s70, s32, 4224
    s_lshl_b32 s25, s3, 9
    s_add_u32 s70, s70, s25
    s_add_u32 s70, s70, 720896
    v_lshlrev_b32 v3, 2, v0
    s_waitcnt lgkmcnt(0)
    s_mov_b64 exec, 0
    s_branch L_fdry
L_fret:
    s_waitcnt vmcnt(0) lgkmcnt(0)
    v_lshlrev_b32 v64, 16, v72
    v_and_b32 v65, 0xffff0000, v72
    v_lshlrev_b32 v66, 16, v73
    v_and_b32 v67, 0xffff0000, v73
    v_lshlrev_b32 v74, 16, v74
    s_barrier
L_fdry:
    s_cmp_ge_u32 s3, 4
    s_cbranch_scc1 L_F1
    ds_read_b64_tr_b16 v[16:17], v104 offset:0
    ds_read_b64_tr_b16 v[18:19], v104 offset:1024
    ds_read_b64_tr_b16 v[20:21], v104 offset:512
    ds_read_b64_tr_b16 v[22:23], v104 offset:1536
    ds_read_b64_tr_b16 v[24:25], v104 offset:2048
    ds_read_b64_tr_b16 v[26:27], v104 offset:3072
    ds_read_b64_tr_b16 v[28:29], v104 offset:2560
    ds_read_b64_tr_b16 v[30:31], v104 offset:3584
    ds_read_b64_tr_b16 v[32:33], v104 offset:4096
    ds_read_b64_tr_b16 v[34:35], v104 offset:5120
    ds_read_b64_tr_b16 v[36:37], v104 offset:4608
    ds_read_b64_tr_b16 v[38:39], v104 offset:5632
    ds_read_b64_tr_b16 v[40:41], v104 offset:6144
    ds_read_b64_tr_b16 v[42:43], v104 offset:7168
    ds_read_b64_tr_b16 v[44:45], v104 offset:6656
    ds_read_b64_tr_b16 v[46:47], v104 offset:7680
    s_waitcnt lgkmcnt(0)
    ds_read_b64_tr_b16 v[128:129], v118 offset:0
    ds_read_b64_tr_b16 v[130:131], v118 offset:4096
    ds_read_b64_tr_b16 v[132:133], v119 offset:0
    ds_read_b64_tr_b16 v[134:135], v119 offset:4096
    ds_read_b64_tr_b16 v[136:137], v118 offset:256
    ds_read_b64_tr_b16 v[138:139], v118 offset:4352
    ds_read_b64_tr_b16 v[140:141], v119 offset:256
    ds_read_b64_tr_b16 v[142:143], v119 offset:4352
    ds_read_b64_tr_b16 v[144:145], v118 offset:512
    ds_read_b64_tr_b16 v[146:147], v118 offset:4608
    ds_read_b64_tr_b16 v[148:149], v119 offset:512
    ds_read_b64_tr_b16 v[150:151], v119 offset:4608
    ds_read_b64_tr_b16 v[152:153], v118 offset:768
    ds_read_b64_tr_b16 v[154:155], v118 offset:4864
    ds_read_b64_tr_b16 v[156:157], v119 offset:768
    ds_read_b64_tr_b16 v[158:159], v119 offset:4864
L_F1:
    s_mov_b32 s30, 262144
Lt_47:
    s_cbranch_execz L_sk10
    buffer_load_dwordx4 v[48:51], v84, s[8:11], s62 offen sc1
    buffer_load_dwordx4 v[52:55], v84, s[8:11], s63 offen sc1
    buffer_load_dwordx4 v[56:59], v84, s[8:11], s64 offen sc1
    buffer_load_dwordx4 v[60:63], v84, s[8:11], s65 offen sc1
L_sk10:
    s_sub_u32 s30, s30, 1
    s_cbranch_scc1 Lte_48
    s_waitcnt vmcnt(0)
    v_xor_b32 v48, v48, v124
    v_xor_b32 v49, v49, v125
    v_xor_b32 v50, v50, v126
    v_xor_b32 v51, v51, v127
    v_xor_b32 v52, v52, v124
    v_xor_b32 v53, v53, v125
    v_xor_b32 v54, v54, v126
    v_xor_b32 v55, v55, v127
    v_xor_b32 v56, v56, v124
    v_xor_b32 v57, v57, v125
    v_xor_b32 v58, v58, v126
    v_xor_b32 v59, v59, v127
    v_xor_b32 v60, v60, v124
    v_xor_b32 v61, v61, v125
    v_xor_b32 v62, v62, v126
    v_xor_b32 v63, v63, v127
    v_or3_b32 v104, v48, v49, v50
    v_or3_b32 v104, v104, v51, v52
    v_or3_b32 v104, v104, v53, v54
    v_or3_b32 v104, v104, v55, v56
    v_or3_b32 v104, v104, v57, v58
    v_or3_b32 v104, v104, v59, v60
    v_or3_b32 v104, v104, v61, v62
    v_or_b32 v104, v104, v63
    v_and_b32 v104, v5, v104
    v_cmp_ne_u32 vcc, 0, v104
    s_cmp_lg_u64 vcc, 0
    s_cbranch_scc1 Lt_47
Lte_48:
    s_waitcnt vmcnt(0)
    v_pk_add_f32 v[48:49], v[48:49], v[52:53]
    v_pk_add_f32 v[56:57], v[56:57], v[60:61]
    v_pk_add_f32 v[50:51], v[50:51], v[54:55]
    v_pk_add_f32 v[58:59], v[58:59], v[62:63]
    v_pk_add_f32 v[48:49], v[48:49], v[56:57]
    v_pk_add_f32 v[50:51], v[50:51], v[58:59]
    v_mov_b32 v52, v48
    v_mov_b32 v53, v49
    v_mov_b32 v54, v50
    v_mov_b32 v55, v51
    v_permlane32_swap_b32 v48, v52
    v_permlane32_swap_b32 v49, v53
    v_permlane32_swap_b32 v50, v54
    v_permlane32_swap_b32 v51, v55
    v_add_f32 v48, v48, v52
    v_add_f32 v49, v49, v53
    v_add_f32 v50, v50, v54
    v_add_f32 v51, v51, v55
    v_cvt_pk_bf16_f32 v56, v48, v49
    v_cvt_pk_bf16_f32 v57, v50, v51
    v_lshlrev_b32 v48, 16, v56
    v_and_b32 v49, 0xffff0000, v56
    v_lshlrev_b32 v50, 16, v57
    v_and_b32 v51, 0xffff0000, v57
    v_add_f32 v64, v64, v48
    v_add_f32 v65, v65, v49
    v_add_f32 v66, v66, v50
    v_add_f32 v67, v67, v51
    v_cvt_pk_bf16_f32 v56, v64, v65
    v_cvt_pk_bf16_f32 v57, v66, v67
    v_lshlrev_b32 v64, 16, v56
    v_and_b32 v65, 0xffff0000, v56
    v_lshlrev_b32 v66, 16, v57
    v_and_b32 v67, 0xffff0000, v57
    s_nop 0
    v_readfirstlane_b32 s26, v64
    s_nop 1
    v_subrev_f32 v48, s26, v64
    v_subrev_f32 v49, s26, v65
    v_subrev_f32 v50, s26, v66
    v_subrev_f32 v51, s26, v67
    v_add_f32 v58, v48, v49
    v_mul_f32 v59, v48, v48
    v_add_f32 v52, v50, v51
    v_fmac_f32 v59, v49, v49
    v_add_f32 v58, v58, v52
    v_fmac_f32 v59, v50, v50
    v_fmac_f32 v59, v51, v51
    s_nop 0
    s_nop 0
    v_add_f32_dpp v58, v58, v58 quad_perm:[1,0,3,2] row_mask:0xf bank_mask:0xf
    v_add_f32_dpp v59, v59, v59 quad_perm:[1,0,3,2] row_mask:0xf bank_mask:0xf
    s_nop 0
    v_add_f32_dpp v58, v58, v58 quad_perm:[2,3,0,1] row_mask:0xf bank_mask:0xf
    v_add_f32_dpp v59, v59, v59 quad_perm:[2,3,0,1] row_mask:0xf bank_mask:0xf
    s_nop 0
    v_add_f32_dpp v58, v58, v58 row_half_mirror row_mask:0xf bank_mask:0xf
    v_add_f32_dpp v59, v59, v59 row_half_mirror row_mask:0xf bank_mask:0xf
    s_nop 0
    v_add_f32_dpp v58, v58, v58 row_mirror row_mask:0xf bank_mask:0xf
    v_add_f32_dpp v59, v59, v59 row_mirror row_mask:0xf bank_mask:0xf
    v_mov_b32 v52, v58
    v_mov_b32 v53, v59
    s_nop 0
    v_permlane16_swap_b32 v58, v52
    v_permlane16_swap_b32 v59, v53
    v_add_f32 v58, v58, v52
    v_add_f32 v59, v59, v53
    v_mul_f32 v52, 0x3c000000, v58
    v_fma_f32 v59, -v52, v58, v59
    v_add_f32 v58, s26, v52
    s_cbranch_execz L_sk11
    s_mov_b64 exec, 1
    ds_write_b64 v86, v[58:59] offset:8192
    s_mov_b64 exec, -1
L_sk11:
    s_mov_b32 s30, 262144
Lst_49:
    ds_read_b128 v[48:51], v87 offset:8192
    ds_read_b128 v[52:55], v87 offset:8208
    s_sub_u32 s30, s30, 1
    s_cbranch_scc1 Lste_50
    s_waitcnt lgkmcnt(0)
    v_max3_u32 v104, v48, v49, v50
    v_max3_u32 v104, v104, v51, v52
    v_max3_u32 v104, v104, v53, v54
    v_max_u32 v104, v104, v55
    v_cmp_eq_u32 vcc, -1, v104
    s_cmp_lg_u64 vcc, 0
    s_cbranch_scc1 Lst_49
Lste_50:
    s_waitcnt lgkmcnt(0)
    v_add_f32 v56, v48, v50
    v_add_f32 v58, v52, v54
    v_add_f32 v57, v49, v51
    v_add_f32 v56, v56, v58
    v_add_f32 v58, v53, v55
    v_mul_f32 v56, 0x3e800000, v56
    v_add_f32 v57, v57, v58
    v_sub_f32 v48, v48, v56
    v_sub_f32 v50, v50, v56
    v_sub_f32 v52, v52, v56
    v_sub_f32 v54, v54, v56
    v_mul_f32 v58, v48, v48
    v_fmac_f32 v58, v50, v50
    v_fmac_f32 v58, v52, v52
    v_fmac_f32 v58, v54, v54
    v_mul_f32 v57, 0x3b000000, v57
    v_fmac_f32 v57, 0x3e800000, v58
    v_cvt_pk_bf16_f32 v56, v56, v56
    v_lshlrev_b32 v56, 16, v56
    v_cvt_pk_bf16_f32 v57, v57, v57
    v_lshlrev_b32 v57, 16, v57
    v_sub_f32 v48, v64, v56
    v_sub_f32 v49, v65, v56
    v_sub_f32 v50, v66, v56
    v_sub_f32 v51, v67, v56
    v_add_f32 v57, 0x3727c5ac, v57
    v_cvt_pk_bf16_f32 v60, v48, v49
    v_cvt_pk_bf16_f32 v61, v50, v51
    v_cvt_pk_bf16_f32 v57, v57, v57
    v_lshlrev_b32 v57, 16, v57
    v_lshlrev_b32 v48, 16, v60
    v_and_b32 v49, 0xffff0000, v60
    v_lshlrev_b32 v50, 16, v61
    v_and_b32 v51, 0xffff0000, v61
    v_sqrt_f32 v57, v57
    s_nop 0
    v_cvt_pk_bf16_f32 v57, v57, v57
    v_lshlrev_b32 v57, 16, v57
    v_rcp_f32 v57, v57
    s_nop 0
    v_mul_f32 v48, v48, v57
    v_mul_f32 v49, v49, v57
    v_mul_f32 v50, v50, v57
    v_mul_f32 v51, v51, v57
    v_cvt_pk_bf16_f32 v60, v48, v49
    v_cvt_pk_bf16_f32 v61, v50, v51
    s_cbranch_execz L_sk12
    s_mov_b32 exec_hi, 0
    ds_write_b64 v85, v[60:61] offset:4096
    s_mov_b32 exec_hi, -1
L_sk12:
    s_mov_b32 s25, 0xbdd2d3e8
    v_mov_b32 v104, 0xc0135761
    s_waitcnt lgkmcnt(0)
    s_cbranch_execz L_sk13
    s_barrier
L_sk13:
    s_cmp_ge_u32 s3, 4
    s_cbranch_scc1 L_exit_3
    ds_read_b128 v[48:51], v120 offset:4096
    ds_read_b128 v[52:55], v120 offset:4160
    ds_read_b128 v[56:59], v120 offset:4224
    ds_read_b128 v[60:63], v120 offset:4288
    s_waitcnt lgkmcnt(3)
    v_mfma_f32_16x16x32_bf16 v[64:67], v[16:19], v[48:51], 0
    v_mfma_f32_16x16x32_bf16 v[68:71], v[20:23], v[48:51], 0
    s_waitcnt lgkmcnt(2)
    v_mfma_f32_16x16x32_bf16 v[64:67], v[24:27], v[52:55], v[64:67]
    v_mfma_f32_16x16x32_bf16 v[68:71], v[28:31], v[52:55], v[68:71]
    s_waitcnt lgkmcnt(1)
    v_mfma_f32_16x16x32_bf16 v[64:67], v[32:35], v[56:59], v[64:67]
    v_mfma_f32_16x16x32_bf16 v[68:71], v[36:39], v[56:59], v[68:71]
    s_waitcnt lgkmcnt(0)
    v_mfma_f32_16x16x32_bf16 v[64:67], v[40:43], v[60:63], v[64:67]
    v_mfma_f32_16x16x32_bf16 v[68:71], v[44:47], v[60:63], v[68:71]
    s_nop 5
    s_cbranch_execz L_sk14
    s_mov_b32 exec_lo, 0x30003
    s_mov_b32 exec_hi, 0x30003
    ds_write_b128 v121, v[64:67] offset:6144
    ds_write_b128 v121, v[68:71] offset:6208
    s_mov_b64 exec, -1
L_sk14:
    s_waitcnt lgkmcnt(0)
    s_cbranch_execz L_sk15
    s_barrier
L_sk15:
    ds_read_b32 v16, v3 offset:6144
    ds_read_b32 v17, v3 offset:6400
    ds_read_b32 v18, v3 offset:6656
    ds_read_b32 v19, v3 offset:6912
    s_waitcnt lgkmcnt(0)
    v_add_f32 v16, v16, v17
    v_add_f32 v18, v18, v19
    v_add_f32 v16, v16, v18
    v_cvt_pk_bf16_f32 v16, v16, v16
    v_lshlrev_b32 v16, 16, v16
    v_add_f32 v16, v16, v74
    v_cvt_pk_bf16_f32 v16, v16, v16
    v_lshlrev_b32 v16, 16, v16
    v_mul_f32 v17, v16, v16
    v_fma_f32 v17, v17, s25, v104
    v_mul_f32 v17, v17, v16
    v_exp_f32 v17, v17
    s_nop 0
    v_add_f32 v17, 1.0, v17
    v_rcp_f32 v17, v17
    s_nop 0
    v_mul_f32 v16, v16, v17
    v_cvt_pk_bf16_f32 v16, v16, v16
    ds_write_b16 v122, v16
    ds_read_b128 v[32:35], v108
    ds_read_b128 v[36:39], v109
    ds_read_b128 v[40:43], v110
    ds_read_b128 v[44:47], v111
    ds_read_b128 v[48:51], v112
    ds_read_b128 v[52:55], v113
    ds_read_b128 v[56:59], v114
    ds_read_b128 v[60:63], v115
    s_waitcnt lgkmcnt(7)
    v_mfma_f32_16x16x32_bf16 v[24:27], v[128:131], v[32:35], 0
    s_waitcnt lgkmcnt(6)
    v_mfma_f32_16x16x32_bf16 v[24:27], v[132:135], v[36:39], v[24:27]
    s_waitcnt lgkmcnt(5)
    v_mfma_f32_16x16x32_bf16 v[24:27], v[136:139], v[40:43], v[24:27]
    s_waitcnt lgkmcnt(4)
    v_mfma_f32_16x16x32_bf16 v[24:27], v[140:143], v[44:47], v[24:27]
    s_waitcnt lgkmcnt(3)
    v_mfma_f32_16x16x32_bf16 v[24:27], v[144:147], v[48:51], v[24:27]
    s_waitcnt lgkmcnt(2)
    v_mfma_f32_16x16x32_bf16 v[24:27], v[148:151], v[52:55], v[24:27]
    s_waitcnt lgkmcnt(1)
    v_mfma_f32_16x16x32_bf16 v[24:27], v[152:155], v[56:59], v[24:27]
    s_waitcnt lgkmcnt(0)
    v_mfma_f32_16x16x32_bf16 v[24:27], v[156:159], v[60:63], v[24:27]
    s_nop 7
    v_add_u32 v24, 0x200, v24
    v_add_u32 v25, 0x200, v25
    v_add_u32 v26, 0x200, v26
    v_add_u32 v27, 0x200, v27
    v_bfi_b32 v24, v5, v124, v24
    v_bfi_b32 v25, v5, v125, v25
    v_bfi_b32 v26, v5, v126, v26
    v_bfi_b32 v27, v5, v127, v27
    s_cbranch_execz L_sk16
    buffer_store_dwordx4 v[24:27], v123, s[8:11], s70 offen sc1
L_sk16:
    s_branch L_exit_3
L_exit_1:
    s_cbranch_execnz L_exit
    s_mov_b64 exec, -1
    s_branch L_kret
L_exit_2:
    s_cbranch_execnz L_exit
    s_mov_b64 exec, -1
    s_branch L_eret
L_exit_3:
    s_cbranch_execnz L_exit
    s_mov_b64 exec, -1
    s_branch L_fret
L_exit:
L_end:
    s_endpgm
.section .rodata,"a"
.p2align 6
.amdhsa_kernel sequential_preLN__sliding_block_cached__dense_activation_gelu__decode_kernel
  .amdhsa_next_free_vgpr 168
  .amdhsa_next_free_sgpr 102
  .amdhsa_accum_offset 168
  .amdhsa_group_segment_fixed_size 0
  .amdhsa_kernarg_size 104
  .amdhsa_user_sgpr_count 2
  .amdhsa_user_sgpr_kernarg_segment_ptr 1
  .amdhsa_system_sgpr_workgroup_id_x 1
.end_amdhsa_kernel
```
